```python
import torch

def _softmax(x, axis=-1):
    return torch.softmax(x, dim=axis)
def _gelu(x):
    return torch.nn.functional.gelu(x, approximate="tanh")
def _silu(x):
    return torch.nn.functional.silu(x)
def _sigmoid(x):
    return torch.sigmoid(x)
def _layernorm(x, axis=-1, eps=1e-5):
    m = x.mean(dim=axis, keepdim=True)
    v = x.var(dim=axis, keepdim=True, unbiased=False)
    return (x - m) / torch.sqrt(v + eps)
def _scatter_add(tgt, idx, src, axis=0):
    return tgt.clone().index_add_(axis, idx, src)
def _segment_sum(src, seg, n):
    out = torch.zeros((n,) + src.shape[1:], dtype=src.dtype)
    return out.index_add_(0, seg, src)
def _pad(x, pw):
    flat = tuple(v for pair in reversed(pw) for v in pair)
    return torch.nn.functional.pad(x, flat)

kernel_name = 'sequential_preLN__mha_block_cached__glu_gated_reglu__decode'

def setup_inputs():

    _w = (lambda a: (lambda t: t.to(torch.bfloat16) if t.is_floating_point() else t)(torch.as_tensor(a)))
    def _A_setup():
        B, Sq, D = 1, 1, 640
        H, Sk, Dh = 32, 8192, 192
        return {
            "x": _w((lambda *s: torch.randn(*s, dtype=torch.bfloat16) * 0.05)(B, Sq, D)),
            "k_cache": _w((lambda *s: torch.randn(*s, dtype=torch.bfloat16) * 1.6)(B, H, Sk, Dh)),
            "v_cache": _w((lambda *s: torch.randn(*s, dtype=torch.bfloat16) * 0.8)(B, H, Sk, Dh)),
            "wq": _w((lambda *s: torch.randn(*s, dtype=torch.bfloat16) * 1.6)(D, H * Dh) * (D ** -0.5)),
            "wo": _w((lambda *s: torch.randn(*s, dtype=torch.bfloat16) * 0.8)(H * Dh, D) * ((H * Dh) ** -0.5)),
        }
    _A_in = _A_setup()

    def _B_setup():
        B, S, D, F = 1, 1, 640, 1536
        return {
            "x": _w((lambda *s: torch.randn(*s, dtype=torch.bfloat16) * 0.05)(B, S, D)),
            "W_gate": _w((lambda *s: torch.randn(*s, dtype=torch.bfloat16) * 0.4)(D, F) * (2.0 / D) ** 0.5),
            "W_up": _w((lambda *s: torch.randn(*s, dtype=torch.bfloat16) * 0.4)(D, F) * (2.0 / D) ** 0.5),
            "W_down": _w((lambda *s: torch.randn(*s, dtype=torch.bfloat16) * 0.4)(F, D) * (1.0 / F) ** 0.5),
        }
    _B_in = _B_setup()

    return {
        "A_x": _A_in["x"],
        "A_k_cache": _A_in["k_cache"],
        "A_v_cache": _A_in["v_cache"],
        "A_wq": _A_in["wq"],
        "A_wo": _A_in["wo"],
        "B_x": _B_in["x"],
        "B_W_gate": _B_in["W_gate"],
        "B_W_up": _B_in["W_up"],
        "B_W_down": _B_in["W_down"],
    }

def reference(A_x, A_k_cache, A_v_cache, A_wq, A_wo, B_x, B_W_gate, B_W_up, B_W_down):
    def _A_ref(x, k_cache, v_cache, wq, wo):
        B, Sq, D = x.shape
        H, Dh = 32, 192
        q = (lambda x, *d: x.permute(*d))((x @ wq).reshape(B, Sq, H, Dh), 0, 2, 1, 3)
        scores = torch.einsum("bhqd,bhkd->bhqk", q, k_cache) * (Dh ** -0.5)
        p = _softmax(scores, axis=-1)
        o = torch.einsum("bhqk,bhkd->bhqd", p, v_cache)
        return (lambda x, *d: x.permute(*d))(o, 0, 2, 1, 3).reshape(B, Sq, H * Dh) @ wo

    def _B_ref(x, W_gate, W_up, W_down):
        gate = torch.einsum("bsd,df->bsf", x, W_gate)
        up = torch.einsum("bsd,df->bsf", x, W_up)
        gate = gate * (lambda x, dt: x.to(dt))(gate > 0, gate.dtype)
        h = gate * up
        return torch.einsum("bsf,fd->bsd", h, W_down)

    x = A_x
    h = x + _A_ref(_layernorm(x, axis=-1), A_k_cache, A_v_cache, A_wq, A_wo)
    h2 = h + _B_ref(_layernorm(h, axis=-1), B_W_gate, B_W_up, B_W_down)
    return h2
```

```asm
; @launch grid=(256,1,1) block=(512,1,1) lds=62464
.amdgcn_target "amdgcn-amd-amdhsa--gfx950"
.text
.globl sequential_preLN__mha_block_cached__glu_gated_reglu__decode_kernel
.p2align 8
.type sequential_preLN__mha_block_cached__glu_gated_reglu__decode_kernel,@function
sequential_preLN__mha_block_cached__glu_gated_reglu__decode_kernel:
  s_cmp_ge_u32 s2, 256
  s_cbranch_scc1 L_end
  s_load_dwordx16 s[16:31], s[0:1], 0
  s_load_dwordx8 s[32:39], s[0:1], 64
  v_lshrrev_b32 v1, 6, v0
  v_and_b32 v0, 63, v0
  v_readfirstlane_b32 s3, v1
  s_and_b32 s5, s2, 7
  s_lshr_b32 s6, s2, 3
  v_lshrrev_b32 v1, 3, v0
  v_and_b32 v2, 7, v0
  s_cmp_ge_u32 s3, 4
  s_cbranch_scc1 L_service
  v_mul_u32_u24 v1, 384, v1
  v_lshl_add_u32 v1, v2, 4, v1
  s_mul_i32 s4, s6, 3145728
  s_lshr_b32 m0, s6, 2
  s_mov_b32 s60, 0x0043a0ee
  s_mov_b32 s61, 0xf14c9e4f
  s_mov_b32 s62, 0xe53490e5
  s_mov_b32 s63, 0xce266f7d
  s_mov_b32 s64, 0x1b1a6ab8
  s_mov_b32 s65, 0xb8105ab0
  s_mov_b32 s66, 0x610d6108
  s_mov_b32 s67, 0x07135db5
  s_movrels_b32 s7, s60
  s_lshl_b32 s8, s6, 3
  s_lshr_b32 s7, s7, s8
  s_and_b32 s7, s7, 0xff
  s_lshl_b32 s7, s7, 2
  s_lshl_b32 s8, s5, 2
  s_lshr_b32 s8, 0x45673210, s8
  s_and_b32 s8, s8, 7
  s_lshl_b32 s8, s8, 2
  s_add_u32 s8, s8, s3
  s_bfe_u32 s100, s8, 0x10005
  s_bfe_u32 s101, s8, 0x20003
  s_lshl_b32 s101, s101, 1
  s_or_b32 s100, s100, s101
  s_lshl_b32 s100, s100, 3
  s_and_b32 s101, s8, 0xffffffc7
  s_or_b32 s100, s100, s101
  s_add_u32 s52, s100, s7
  s_and_b32 s52, s52, 1023
  s_mul_i32 s52, s52, 3072
  s_waitcnt lgkmcnt(0)
  s_add_u32 s40, s18, s4
  s_addc_u32 s41, s19, 0
  s_mov_b32 s42, 3145728
  s_mov_b32 s43, 0x20000
  s_mov_b32 s9, s8
  buffer_load_dwordx4 v[96:99], v1, s[40:43], s52 offen offset:0 nt
  buffer_load_dwordx4 v[100:103], v1, s[40:43], s52 offen offset:128 nt
  buffer_load_dwordx4 v[104:107], v1, s[40:43], s52 offen offset:256 nt
  s_add_u32 s8, s8, 32
  s_bfe_u32 s100, s8, 0x10005
  s_bfe_u32 s101, s8, 0x20003
  s_lshl_b32 s101, s101, 1
  s_or_b32 s100, s100, s101
  s_lshl_b32 s100, s100, 3
  s_and_b32 s101, s8, 0xffffffc7
  s_or_b32 s100, s100, s101
  s_add_u32 s52, s100, s7
  s_and_b32 s52, s52, 1023
  s_mul_i32 s52, s52, 3072
  buffer_load_dwordx4 v[108:111], v1, s[40:43], s52 offen offset:0 nt
  buffer_load_dwordx4 v[112:115], v1, s[40:43], s52 offen offset:128 nt
  buffer_load_dwordx4 v[116:119], v1, s[40:43], s52 offen offset:256 nt
  s_add_u32 s44, s20, s4
  s_addc_u32 s45, s21, 0
  s_mov_b32 s46, 3145728
  s_mov_b32 s47, 0x20000
  s_add_u32 s64, s18, s4
  s_addc_u32 s65, s19, 0
  s_mov_b32 s66, 3145728
  s_mov_b32 s67, 0x20000
  s_mov_b32 s48, s38
  s_mov_b32 s49, s39
  s_mov_b32 s50, 2097152
  s_mov_b32 s51, 0x20000
  v_mov_b32 v14, 0
  v_mov_b32 v15, 0
  v_mov_b32 v16, 0
  v_mov_b32 v17, 0
  v_mov_b32 v18, 0
  v_mov_b32 v19, 0
  v_mov_b32 v20, 0
  v_mov_b32 v21, 0
  v_mov_b32 v22, 0
  v_mov_b32 v23, 0
  v_mov_b32 v24, 0
  v_mov_b32 v25, 0
  v_mov_b32 v26, 0
  v_mov_b32 v27, 0
  v_mov_b32 v28, 0
  v_mov_b32 v29, 0
  v_mov_b32 v30, 0
  v_mov_b32 v31, 0
  v_mov_b32 v32, 0
  v_mov_b32 v33, 0
  v_mov_b32 v34, 0
  v_mov_b32 v35, 0
  v_mov_b32 v36, 0
  v_mov_b32 v37, 0
  v_mov_b32 v38, 0
  v_mov_b32 v39, 0xff7fffff
  s_mov_b32 s54, 0xff7fffff
  s_mov_b32 s55, 1033096506
  s_mov_b32 s56, 1069066811
  v_lshlrev_b32 v44, 4, v2
  v_mov_b32 v45, 512
  v_mov_b32 v46, 1
  s_mul_i32 s10, s6, 384
  s_add_u32 s10, s10, 622592
  s_add_u32 s10, s38, s10
  s_addc_u32 s11, s39, 0
  s_getpc_b64 s[58:59]
L_pc0:
  s_add_u32 s58, s58, L_rescale-L_pc0
  s_addc_u32 s59, s59, 0
  s_barrier
  s_add_u32 s8, s8, 32
  s_bfe_u32 s100, s8, 0x10005
  s_bfe_u32 s101, s8, 0x20003
  s_lshl_b32 s101, s101, 1
  s_or_b32 s100, s100, s101
  s_lshl_b32 s100, s100, 3
  s_and_b32 s101, s8, 0xffffffc7
  s_or_b32 s100, s100, s101
  s_add_u32 s52, s100, s7
  s_and_b32 s52, s52, 1023
  s_mul_i32 s52, s52, 3072
  s_waitcnt vmcnt(3)
  buffer_load_dwordx4 v[120:123], v1, s[40:43], s52 offen offset:0 nt
  buffer_load_dwordx4 v[124:127], v1, s[40:43], s52 offen offset:128 nt
  buffer_load_dwordx4 v[128:131], v1, s[40:43], s52 offen offset:256 nt
  s_add_u32 s8, s8, 32
  s_bfe_u32 s100, s8, 0x10005
  s_bfe_u32 s101, s8, 0x20003
  s_lshl_b32 s101, s101, 1
  s_or_b32 s100, s100, s101
  s_lshl_b32 s100, s100, 3
  s_and_b32 s101, s8, 0xffffffc7
  s_or_b32 s100, s100, s101
  s_add_u32 s52, s100, s7
  s_and_b32 s52, s52, 1023
  s_mul_i32 s52, s52, 3072
  s_waitcnt vmcnt(3)
  buffer_load_dwordx4 v[132:135], v1, s[40:43], s52 offen offset:0 nt
  buffer_load_dwordx4 v[136:139], v1, s[40:43], s52 offen offset:128 nt
  buffer_load_dwordx4 v[140:143], v1, s[40:43], s52 offen offset:256 nt
  s_add_u32 s8, s8, 32
  s_bfe_u32 s100, s8, 0x10005
  s_bfe_u32 s101, s8, 0x20003
  s_lshl_b32 s101, s101, 1
  s_or_b32 s100, s100, s101
  s_lshl_b32 s100, s100, 3
  s_and_b32 s101, s8, 0xffffffc7
  s_or_b32 s100, s100, s101
  s_add_u32 s52, s100, s7
  s_and_b32 s52, s52, 1023
  s_mul_i32 s52, s52, 3072
  s_waitcnt vmcnt(3)
  buffer_load_dwordx4 v[144:147], v1, s[40:43], s52 offen offset:0 nt
  buffer_load_dwordx4 v[148:151], v1, s[40:43], s52 offen offset:128 nt
  buffer_load_dwordx4 v[152:155], v1, s[40:43], s52 offen offset:256 nt
  s_add_u32 s8, s8, 32
  s_bfe_u32 s100, s8, 0x10005
  s_bfe_u32 s101, s8, 0x20003
  s_lshl_b32 s101, s101, 1
  s_or_b32 s100, s100, s101
  s_lshl_b32 s100, s100, 3
  s_and_b32 s101, s8, 0xffffffc7
  s_or_b32 s100, s100, s101
  s_add_u32 s52, s100, s7
  s_and_b32 s52, s52, 1023
  s_mul_i32 s52, s52, 3072
  s_waitcnt vmcnt(3)
  buffer_load_dwordx4 v[156:159], v1, s[40:43], s52 offen offset:0 nt
  buffer_load_dwordx4 v[160:163], v1, s[40:43], s52 offen offset:128 nt
  buffer_load_dwordx4 v[164:167], v1, s[40:43], s52 offen offset:256 nt
  ds_write_b32 v45, v46 offset:16
  s_add_u32 s8, s8, 32
  s_bfe_u32 s100, s8, 0x10005
  s_bfe_u32 s101, s8, 0x20003
  s_lshl_b32 s101, s101, 1
  s_or_b32 s100, s100, s101
  s_lshl_b32 s100, s100, 3
  s_and_b32 s101, s8, 0xffffffc7
  s_or_b32 s100, s100, s101
  s_add_u32 s52, s100, s7
  s_and_b32 s52, s52, 1023
  s_mul_i32 s52, s52, 3072
  s_waitcnt vmcnt(3)
  buffer_load_dwordx4 v[168:171], v1, s[40:43], s52 offen offset:0 nt
  buffer_load_dwordx4 v[172:175], v1, s[40:43], s52 offen offset:128 nt
  buffer_load_dwordx4 v[176:179], v1, s[40:43], s52 offen offset:256 nt
  s_add_u32 s8, s8, 32
  s_bfe_u32 s100, s8, 0x10005
  s_bfe_u32 s101, s8, 0x20003
  s_lshl_b32 s101, s101, 1
  s_or_b32 s100, s100, s101
  s_lshl_b32 s100, s100, 3
  s_and_b32 s101, s8, 0xffffffc7
  s_or_b32 s100, s100, s101
  s_add_u32 s52, s100, s7
  s_and_b32 s52, s52, 1023
  s_mul_i32 s52, s52, 3072
  s_waitcnt vmcnt(3)
  buffer_load_dwordx4 v[180:183], v1, s[40:43], s52 offen offset:0 nt
  buffer_load_dwordx4 v[184:187], v1, s[40:43], s52 offen offset:128 nt
  buffer_load_dwordx4 v[188:191], v1, s[40:43], s52 offen offset:256 nt
  s_add_u32 s8, s8, 32
  s_bfe_u32 s100, s8, 0x10005
  s_bfe_u32 s101, s8, 0x20003
  s_lshl_b32 s101, s101, 1
  s_or_b32 s100, s100, s101
  s_lshl_b32 s100, s100, 3
  s_and_b32 s101, s8, 0xffffffc7
  s_or_b32 s100, s100, s101
  s_add_u32 s52, s100, s7
  s_and_b32 s52, s52, 1023
  s_mul_i32 s52, s52, 3072
  s_waitcnt vmcnt(3)
  buffer_load_dwordx4 v[48:51], v1, s[40:43], s52 offen offset:0 nt
  buffer_load_dwordx4 v[52:55], v1, s[40:43], s52 offen offset:128 nt
  buffer_load_dwordx4 v[56:59], v1, s[40:43], s52 offen offset:256 nt
  s_add_u32 s8, s8, 32
  s_bfe_u32 s100, s8, 0x10005
  s_bfe_u32 s101, s8, 0x20003
  s_lshl_b32 s101, s101, 1
  s_or_b32 s100, s100, s101
  s_lshl_b32 s100, s100, 3
  s_and_b32 s101, s8, 0xffffffc7
  s_or_b32 s100, s100, s101
  s_add_u32 s52, s100, s7
  s_and_b32 s52, s52, 1023
  s_mul_i32 s52, s52, 3072
  s_waitcnt vmcnt(3)
  buffer_load_dwordx4 v[60:63], v1, s[40:43], s52 offen offset:0 nt
  buffer_load_dwordx4 v[64:67], v1, s[40:43], s52 offen offset:128 nt
  buffer_load_dwordx4 v[68:71], v1, s[40:43], s52 offen offset:256 nt
  s_add_u32 s8, s8, 32
  s_bfe_u32 s100, s8, 0x10005
  s_bfe_u32 s101, s8, 0x20003
  s_lshl_b32 s101, s101, 1
  s_or_b32 s100, s100, s101
  s_lshl_b32 s100, s100, 3
  s_and_b32 s101, s8, 0xffffffc7
  s_or_b32 s100, s100, s101
  s_add_u32 s52, s100, s7
  s_and_b32 s52, s52, 1023
  s_mul_i32 s52, s52, 3072
  s_mov_b32 s57, 2097152
L_qwait:
  ds_read_b32 v47, v45 offset:12
  ds_read_b128 v[2:5], v44 offset:0
  ds_read_b128 v[6:9], v44 offset:128
  ds_read_b128 v[10:13], v44 offset:256
  s_sub_u32 s57, s57, 1
  s_cbranch_scc1 L_qok
  s_waitcnt lgkmcnt(0)
  v_cmp_eq_u32 vcc, 0, v47
  s_cbranch_vccnz L_qwait
L_qok:
  s_waitcnt lgkmcnt(0)
  s_waitcnt vmcnt(3)
  buffer_load_dwordx4 v[72:75], v1, s[40:43], s52 offen offset:0 nt
  buffer_load_dwordx4 v[76:79], v1, s[40:43], s52 offen offset:128 nt
  buffer_load_dwordx4 v[80:83], v1, s[40:43], s52 offen offset:256 nt
  s_add_u32 s8, s8, 32
  s_bfe_u32 s100, s8, 0x10005
  s_bfe_u32 s101, s8, 0x20003
  s_lshl_b32 s101, s101, 1
  s_or_b32 s100, s100, s101
  s_lshl_b32 s100, s100, 3
  s_and_b32 s101, s8, 0xffffffc7
  s_or_b32 s100, s100, s101
  s_add_u32 s52, s100, s7
  s_and_b32 s52, s52, 1023
  s_mul_i32 s52, s52, 3072
  v_mov_b32 v40, 0
  v_dot2c_f32_bf16 v40, v96, v2
  v_dot2c_f32_bf16 v40, v97, v3
  v_dot2c_f32_bf16 v40, v98, v4
  v_dot2c_f32_bf16 v40, v99, v5
  v_dot2c_f32_bf16 v40, v100, v6
  v_dot2c_f32_bf16 v40, v101, v7
  v_dot2c_f32_bf16 v40, v102, v8
  v_dot2c_f32_bf16 v40, v103, v9
  v_dot2c_f32_bf16 v40, v104, v10
  v_dot2c_f32_bf16 v40, v105, v11
  v_dot2c_f32_bf16 v40, v106, v12
  v_dot2c_f32_bf16 v40, v107, v13
  s_nop 2
  v_add_f32_dpp v40, v40, v40 quad_perm:[1,0,3,2] row_mask:0xf bank_mask:0xf
  s_nop 1
  v_add_f32_dpp v40, v40, v40 quad_perm:[2,3,0,1] row_mask:0xf bank_mask:0xf
  s_nop 1
  v_add_f32_dpp v40, v40, v40 row_half_mirror row_mask:0xf bank_mask:0xf
  v_cvt_pk_bf16_f32 v40, 0, v40
  v_mul_f32 v40, s55, v40
  v_cvt_pk_bf16_f32 v40, 0, v40
  v_mul_f32 v244, s56, v40
  v_max_f32 v39, v39, v244
  v_mov_b32 v40, 0
  v_dot2c_f32_bf16 v40, v108, v2
  v_dot2c_f32_bf16 v40, v109, v3
  v_dot2c_f32_bf16 v40, v110, v4
  v_dot2c_f32_bf16 v40, v111, v5
  v_dot2c_f32_bf16 v40, v112, v6
  v_dot2c_f32_bf16 v40, v113, v7
  v_dot2c_f32_bf16 v40, v114, v8
  v_dot2c_f32_bf16 v40, v115, v9
  v_dot2c_f32_bf16 v40, v116, v10
  v_dot2c_f32_bf16 v40, v117, v11
  v_dot2c_f32_bf16 v40, v118, v12
  v_dot2c_f32_bf16 v40, v119, v13
  s_nop 2
  v_add_f32_dpp v40, v40, v40 quad_perm:[1,0,3,2] row_mask:0xf bank_mask:0xf
  s_nop 1
  v_add_f32_dpp v40, v40, v40 quad_perm:[2,3,0,1] row_mask:0xf bank_mask:0xf
  s_nop 1
  v_add_f32_dpp v40, v40, v40 row_half_mirror row_mask:0xf bank_mask:0xf
  v_cvt_pk_bf16_f32 v40, 0, v40
  v_mul_f32 v40, s55, v40
  v_cvt_pk_bf16_f32 v40, 0, v40
  v_mul_f32 v245, s56, v40
  v_max_f32 v39, v39, v245
  v_mov_b32 v40, 0
  v_dot2c_f32_bf16 v40, v48, v2
  v_dot2c_f32_bf16 v40, v49, v3
  v_dot2c_f32_bf16 v40, v50, v4
  v_dot2c_f32_bf16 v40, v51, v5
  v_dot2c_f32_bf16 v40, v52, v6
  v_dot2c_f32_bf16 v40, v53, v7
  v_dot2c_f32_bf16 v40, v54, v8
  v_dot2c_f32_bf16 v40, v55, v9
  v_dot2c_f32_bf16 v40, v56, v10
  v_dot2c_f32_bf16 v40, v57, v11
  v_dot2c_f32_bf16 v40, v58, v12
  v_dot2c_f32_bf16 v40, v59, v13
  s_nop 2
  v_add_f32_dpp v40, v40, v40 quad_perm:[1,0,3,2] row_mask:0xf bank_mask:0xf
  s_nop 1
  v_add_f32_dpp v40, v40, v40 quad_perm:[2,3,0,1] row_mask:0xf bank_mask:0xf
  s_nop 1
  v_add_f32_dpp v40, v40, v40 row_half_mirror row_mask:0xf bank_mask:0xf
  v_cvt_pk_bf16_f32 v40, 0, v40
  v_mul_f32 v40, s55, v40
  v_cvt_pk_bf16_f32 v40, 0, v40
  v_mul_f32 v252, s56, v40
  v_max_f32 v39, v39, v252
  s_waitcnt vmcnt(3)
  buffer_load_dwordx4 v[84:87], v1, s[40:43], s52 offen offset:0 nt
  buffer_load_dwordx4 v[88:91], v1, s[40:43], s52 offen offset:128 nt
  buffer_load_dwordx4 v[92:95], v1, s[40:43], s52 offen offset:256 nt
  s_add_u32 s8, s8, 32
  s_bfe_u32 s100, s8, 0x10005
  s_bfe_u32 s101, s8, 0x20003
  s_lshl_b32 s101, s101, 1
  s_or_b32 s100, s100, s101
  s_lshl_b32 s100, s100, 3
  s_and_b32 s101, s8, 0xffffffc7
  s_or_b32 s100, s100, s101
  s_add_u32 s52, s100, s7
  s_and_b32 s52, s52, 1023
  s_mul_i32 s52, s52, 3072
  v_mov_b32 v40, 0
  v_dot2c_f32_bf16 v40, v120, v2
  v_dot2c_f32_bf16 v40, v121, v3
  v_dot2c_f32_bf16 v40, v122, v4
  v_dot2c_f32_bf16 v40, v123, v5
  v_dot2c_f32_bf16 v40, v124, v6
  v_dot2c_f32_bf16 v40, v125, v7
  v_dot2c_f32_bf16 v40, v126, v8
  v_dot2c_f32_bf16 v40, v127, v9
  v_dot2c_f32_bf16 v40, v128, v10
  v_dot2c_f32_bf16 v40, v129, v11
  v_dot2c_f32_bf16 v40, v130, v12
  v_dot2c_f32_bf16 v40, v131, v13
  s_nop 2
  v_add_f32_dpp v40, v40, v40 quad_perm:[1,0,3,2] row_mask:0xf bank_mask:0xf
  s_nop 1
  v_add_f32_dpp v40, v40, v40 quad_perm:[2,3,0,1] row_mask:0xf bank_mask:0xf
  s_nop 1
  v_add_f32_dpp v40, v40, v40 row_half_mirror row_mask:0xf bank_mask:0xf
  v_cvt_pk_bf16_f32 v40, 0, v40
  v_mul_f32 v40, s55, v40
  v_cvt_pk_bf16_f32 v40, 0, v40
  v_mul_f32 v246, s56, v40
  v_max_f32 v39, v39, v246
  v_mov_b32 v40, 0
  v_dot2c_f32_bf16 v40, v132, v2
  v_dot2c_f32_bf16 v40, v133, v3
  v_dot2c_f32_bf16 v40, v134, v4
  v_dot2c_f32_bf16 v40, v135, v5
  v_dot2c_f32_bf16 v40, v136, v6
  v_dot2c_f32_bf16 v40, v137, v7
  v_dot2c_f32_bf16 v40, v138, v8
  v_dot2c_f32_bf16 v40, v139, v9
  v_dot2c_f32_bf16 v40, v140, v10
  v_dot2c_f32_bf16 v40, v141, v11
  v_dot2c_f32_bf16 v40, v142, v12
  v_dot2c_f32_bf16 v40, v143, v13
  s_nop 2
  v_add_f32_dpp v40, v40, v40 quad_perm:[1,0,3,2] row_mask:0xf bank_mask:0xf
  s_nop 1
  v_add_f32_dpp v40, v40, v40 quad_perm:[2,3,0,1] row_mask:0xf bank_mask:0xf
  s_nop 1
  v_add_f32_dpp v40, v40, v40 row_half_mirror row_mask:0xf bank_mask:0xf
  v_cvt_pk_bf16_f32 v40, 0, v40
  v_mul_f32 v40, s55, v40
  v_cvt_pk_bf16_f32 v40, 0, v40
  v_mul_f32 v247, s56, v40
  v_max_f32 v39, v39, v247
  v_mov_b32 v40, 0
  v_dot2c_f32_bf16 v40, v60, v2
  v_dot2c_f32_bf16 v40, v61, v3
  v_dot2c_f32_bf16 v40, v62, v4
  v_dot2c_f32_bf16 v40, v63, v5
  v_dot2c_f32_bf16 v40, v64, v6
  v_dot2c_f32_bf16 v40, v65, v7
  v_dot2c_f32_bf16 v40, v66, v8
  v_dot2c_f32_bf16 v40, v67, v9
  v_dot2c_f32_bf16 v40, v68, v10
  v_dot2c_f32_bf16 v40, v69, v11
  v_dot2c_f32_bf16 v40, v70, v12
  v_dot2c_f32_bf16 v40, v71, v13
  s_nop 2
  v_add_f32_dpp v40, v40, v40 quad_perm:[1,0,3,2] row_mask:0xf bank_mask:0xf
  s_nop 1
  v_add_f32_dpp v40, v40, v40 quad_perm:[2,3,0,1] row_mask:0xf bank_mask:0xf
  s_nop 1
  v_add_f32_dpp v40, v40, v40 row_half_mirror row_mask:0xf bank_mask:0xf
  v_cvt_pk_bf16_f32 v40, 0, v40
  v_mul_f32 v40, s55, v40
  v_cvt_pk_bf16_f32 v40, 0, v40
  v_mul_f32 v253, s56, v40
  v_max_f32 v39, v39, v253
  s_waitcnt vmcnt(3)
  buffer_load_dwordx4 v[48:51], v1, s[40:43], s52 offen offset:0 nt
  buffer_load_dwordx4 v[52:55], v1, s[40:43], s52 offen offset:128 nt
  buffer_load_dwordx4 v[56:59], v1, s[40:43], s52 offen offset:256 nt
  s_add_u32 s8, s8, 32
  s_bfe_u32 s100, s8, 0x10005
  s_bfe_u32 s101, s8, 0x20003
  s_lshl_b32 s101, s101, 1
  s_or_b32 s100, s100, s101
  s_lshl_b32 s100, s100, 3
  s_and_b32 s101, s8, 0xffffffc7
  s_or_b32 s100, s100, s101
  s_add_u32 s52, s100, s7
  s_and_b32 s52, s52, 1023
  s_mul_i32 s52, s52, 3072
  v_mov_b32 v40, 0
  v_dot2c_f32_bf16 v40, v144, v2
  v_dot2c_f32_bf16 v40, v145, v3
  v_dot2c_f32_bf16 v40, v146, v4
  v_dot2c_f32_bf16 v40, v147, v5
  v_dot2c_f32_bf16 v40, v148, v6
  v_dot2c_f32_bf16 v40, v149, v7
  v_dot2c_f32_bf16 v40, v150, v8
  v_dot2c_f32_bf16 v40, v151, v9
  v_dot2c_f32_bf16 v40, v152, v10
  v_dot2c_f32_bf16 v40, v153, v11
  v_dot2c_f32_bf16 v40, v154, v12
  v_dot2c_f32_bf16 v40, v155, v13
  s_nop 2
  v_add_f32_dpp v40, v40, v40 quad_perm:[1,0,3,2] row_mask:0xf bank_mask:0xf
  s_nop 1
  v_add_f32_dpp v40, v40, v40 quad_perm:[2,3,0,1] row_mask:0xf bank_mask:0xf
  s_nop 1
  v_add_f32_dpp v40, v40, v40 row_half_mirror row_mask:0xf bank_mask:0xf
  v_cvt_pk_bf16_f32 v40, 0, v40
  v_mul_f32 v40, s55, v40
  v_cvt_pk_bf16_f32 v40, 0, v40
  v_mul_f32 v248, s56, v40
  v_max_f32 v39, v39, v248
  v_mov_b32 v40, 0
  v_dot2c_f32_bf16 v40, v156, v2
  v_dot2c_f32_bf16 v40, v157, v3
  v_dot2c_f32_bf16 v40, v158, v4
  v_dot2c_f32_bf16 v40, v159, v5
  v_dot2c_f32_bf16 v40, v160, v6
  v_dot2c_f32_bf16 v40, v161, v7
  v_dot2c_f32_bf16 v40, v162, v8
  v_dot2c_f32_bf16 v40, v163, v9
  v_dot2c_f32_bf16 v40, v164, v10
  v_dot2c_f32_bf16 v40, v165, v11
  v_dot2c_f32_bf16 v40, v166, v12
  v_dot2c_f32_bf16 v40, v167, v13
  s_nop 2
  v_add_f32_dpp v40, v40, v40 quad_perm:[1,0,3,2] row_mask:0xf bank_mask:0xf
  s_nop 1
  v_add_f32_dpp v40, v40, v40 quad_perm:[2,3,0,1] row_mask:0xf bank_mask:0xf
  s_nop 1
  v_add_f32_dpp v40, v40, v40 row_half_mirror row_mask:0xf bank_mask:0xf
  v_cvt_pk_bf16_f32 v40, 0, v40
  v_mul_f32 v40, s55, v40
  v_cvt_pk_bf16_f32 v40, 0, v40
  v_mul_f32 v249, s56, v40
  v_max_f32 v39, v39, v249
  v_mov_b32 v40, 0
  v_dot2c_f32_bf16 v40, v72, v2
  v_dot2c_f32_bf16 v40, v73, v3
  v_dot2c_f32_bf16 v40, v74, v4
  v_dot2c_f32_bf16 v40, v75, v5
  v_dot2c_f32_bf16 v40, v76, v6
  v_dot2c_f32_bf16 v40, v77, v7
  v_dot2c_f32_bf16 v40, v78, v8
  v_dot2c_f32_bf16 v40, v79, v9
  v_dot2c_f32_bf16 v40, v80, v10
  v_dot2c_f32_bf16 v40, v81, v11
  v_dot2c_f32_bf16 v40, v82, v12
  v_dot2c_f32_bf16 v40, v83, v13
  s_nop 2
  v_add_f32_dpp v40, v40, v40 quad_perm:[1,0,3,2] row_mask:0xf bank_mask:0xf
  s_nop 1
  v_add_f32_dpp v40, v40, v40 quad_perm:[2,3,0,1] row_mask:0xf bank_mask:0xf
  s_nop 1
  v_add_f32_dpp v40, v40, v40 row_half_mirror row_mask:0xf bank_mask:0xf
  v_cvt_pk_bf16_f32 v40, 0, v40
  v_mul_f32 v40, s55, v40
  v_cvt_pk_bf16_f32 v40, 0, v40
  v_mul_f32 v254, s56, v40
  v_max_f32 v39, v39, v254
  s_waitcnt vmcnt(3)
  buffer_load_dwordx4 v[60:63], v1, s[40:43], s52 offen offset:0 nt
  buffer_load_dwordx4 v[64:67], v1, s[40:43], s52 offen offset:128 nt
  buffer_load_dwordx4 v[68:71], v1, s[40:43], s52 offen offset:256 nt
  s_add_u32 s8, s8, 32
  s_bfe_u32 s100, s8, 0x10005
  s_bfe_u32 s101, s8, 0x20003
  s_lshl_b32 s101, s101, 1
  s_or_b32 s100, s100, s101
  s_lshl_b32 s100, s100, 3
  s_and_b32 s101, s8, 0xffffffc7
  s_or_b32 s100, s100, s101
  s_add_u32 s52, s100, s7
  s_and_b32 s52, s52, 1023
  s_mul_i32 s52, s52, 3072
  v_mov_b32 v40, 0
  v_dot2c_f32_bf16 v40, v168, v2
  v_dot2c_f32_bf16 v40, v169, v3
  v_dot2c_f32_bf16 v40, v170, v4
  v_dot2c_f32_bf16 v40, v171, v5
  v_dot2c_f32_bf16 v40, v172, v6
  v_dot2c_f32_bf16 v40, v173, v7
  v_dot2c_f32_bf16 v40, v174, v8
  v_dot2c_f32_bf16 v40, v175, v9
  v_dot2c_f32_bf16 v40, v176, v10
  v_dot2c_f32_bf16 v40, v177, v11
  v_dot2c_f32_bf16 v40, v178, v12
  v_dot2c_f32_bf16 v40, v179, v13
  s_nop 2
  v_add_f32_dpp v40, v40, v40 quad_perm:[1,0,3,2] row_mask:0xf bank_mask:0xf
  s_nop 1
  v_add_f32_dpp v40, v40, v40 quad_perm:[2,3,0,1] row_mask:0xf bank_mask:0xf
  s_nop 1
  v_add_f32_dpp v40, v40, v40 row_half_mirror row_mask:0xf bank_mask:0xf
  v_cvt_pk_bf16_f32 v40, 0, v40
  v_mul_f32 v40, s55, v40
  v_cvt_pk_bf16_f32 v40, 0, v40
  v_mul_f32 v250, s56, v40
  v_max_f32 v39, v39, v250
  v_mov_b32 v40, 0
  v_dot2c_f32_bf16 v40, v180, v2
  v_dot2c_f32_bf16 v40, v181, v3
  v_dot2c_f32_bf16 v40, v182, v4
  v_dot2c_f32_bf16 v40, v183, v5
  v_dot2c_f32_bf16 v40, v184, v6
  v_dot2c_f32_bf16 v40, v185, v7
  v_dot2c_f32_bf16 v40, v186, v8
  v_dot2c_f32_bf16 v40, v187, v9
  v_dot2c_f32_bf16 v40, v188, v10
  v_dot2c_f32_bf16 v40, v189, v11
  v_dot2c_f32_bf16 v40, v190, v12
  v_dot2c_f32_bf16 v40, v191, v13
  s_nop 2
  v_add_f32_dpp v40, v40, v40 quad_perm:[1,0,3,2] row_mask:0xf bank_mask:0xf
  s_nop 1
  v_add_f32_dpp v40, v40, v40 quad_perm:[2,3,0,1] row_mask:0xf bank_mask:0xf
  s_nop 1
  v_add_f32_dpp v40, v40, v40 row_half_mirror row_mask:0xf bank_mask:0xf
  v_cvt_pk_bf16_f32 v40, 0, v40
  v_mul_f32 v40, s55, v40
  v_cvt_pk_bf16_f32 v40, 0, v40
  v_mul_f32 v251, s56, v40
  v_max_f32 v39, v39, v251
  v_mov_b32 v40, 0
  v_dot2c_f32_bf16 v40, v84, v2
  v_dot2c_f32_bf16 v40, v85, v3
  v_dot2c_f32_bf16 v40, v86, v4
  v_dot2c_f32_bf16 v40, v87, v5
  v_dot2c_f32_bf16 v40, v88, v6
  v_dot2c_f32_bf16 v40, v89, v7
  v_dot2c_f32_bf16 v40, v90, v8
  v_dot2c_f32_bf16 v40, v91, v9
  v_dot2c_f32_bf16 v40, v92, v10
  v_dot2c_f32_bf16 v40, v93, v11
  v_dot2c_f32_bf16 v40, v94, v12
  v_dot2c_f32_bf16 v40, v95, v13
  s_nop 2
  v_add_f32_dpp v40, v40, v40 quad_perm:[1,0,3,2] row_mask:0xf bank_mask:0xf
  s_nop 1
  v_add_f32_dpp v40, v40, v40 quad_perm:[2,3,0,1] row_mask:0xf bank_mask:0xf
  s_nop 1
  v_add_f32_dpp v40, v40, v40 row_half_mirror row_mask:0xf bank_mask:0xf
  v_cvt_pk_bf16_f32 v40, 0, v40
  v_mul_f32 v40, s55, v40
  v_cvt_pk_bf16_f32 v40, 0, v40
  v_mul_f32 v255, s56, v40
  v_max_f32 v39, v39, v255
  s_mov_b32 s15, 4
  .p2align 3
L_kloop:
  s_waitcnt vmcnt(3)
  buffer_load_dwordx4 v[72:75], v1, s[64:67], s52 offen offset:0 nt
  buffer_load_dwordx4 v[76:79], v1, s[64:67], s52 offen offset:128 nt
  buffer_load_dwordx4 v[80:83], v1, s[64:67], s52 offen offset:256 nt
  s_add_u32 s8, s8, 32
  s_bfe_u32 s100, s8, 0x10005
  s_bfe_u32 s101, s8, 0x20003
  s_lshl_b32 s101, s101, 1
  s_or_b32 s100, s100, s101
  s_lshl_b32 s100, s100, 3
  s_and_b32 s101, s8, 0xffffffc7
  s_or_b32 s100, s100, s101
  s_add_u32 s52, s100, s7
  s_and_b32 s52, s52, 1023
  s_mul_i32 s52, s52, 3072
  v_mov_b32 v228, v232
  v_mov_b32 v229, v233
  v_mov_b32 v230, v234
  v_mov_b32 v231, v235
  v_mov_b32 v232, v236
  v_mov_b32 v233, v237
  v_mov_b32 v234, v238
  v_mov_b32 v235, v239
  v_mov_b32 v236, v240
  v_mov_b32 v237, v241
  v_mov_b32 v238, v242
  v_mov_b32 v239, v243
  v_mov_b32 v240, v244
  v_mov_b32 v241, v245
  v_mov_b32 v242, v246
  v_mov_b32 v243, v247
  v_mov_b32 v244, v248
  v_mov_b32 v245, v249
  v_mov_b32 v246, v250
  v_mov_b32 v247, v251
  v_mov_b32 v248, v252
  v_mov_b32 v249, v253
  v_mov_b32 v250, v254
  v_mov_b32 v251, v255
  v_mov_b32 v40, 0
  v_dot2c_f32_bf16 v40, v48, v2
  v_dot2c_f32_bf16 v40, v49, v3
  v_dot2c_f32_bf16 v40, v50, v4
  v_dot2c_f32_bf16 v40, v51, v5
  v_dot2c_f32_bf16 v40, v52, v6
  v_dot2c_f32_bf16 v40, v53, v7
  v_dot2c_f32_bf16 v40, v54, v8
  v_dot2c_f32_bf16 v40, v55, v9
  v_dot2c_f32_bf16 v40, v56, v10
  v_dot2c_f32_bf16 v40, v57, v11
  v_dot2c_f32_bf16 v40, v58, v12
  v_dot2c_f32_bf16 v40, v59, v13
  s_nop 2
  v_add_f32_dpp v40, v40, v40 quad_perm:[1,0,3,2] row_mask:0xf bank_mask:0xf
  s_nop 1
  v_add_f32_dpp v40, v40, v40 quad_perm:[2,3,0,1] row_mask:0xf bank_mask:0xf
  s_nop 1
  v_add_f32_dpp v40, v40, v40 row_half_mirror row_mask:0xf bank_mask:0xf
  v_cvt_pk_bf16_f32 v40, 0, v40
  v_mul_f32 v40, s55, v40
  v_cvt_pk_bf16_f32 v40, 0, v40
  v_mul_f32 v252, s56, v40
  v_max_f32 v39, v39, v252
  s_waitcnt vmcnt(3)
  buffer_load_dwordx4 v[84:87], v1, s[64:67], s52 offen offset:0 nt
  buffer_load_dwordx4 v[88:91], v1, s[64:67], s52 offen offset:128 nt
  buffer_load_dwordx4 v[92:95], v1, s[64:67], s52 offen offset:256 nt
  s_add_u32 s8, s8, 32
  v_mov_b32 v40, 0
  v_dot2c_f32_bf16 v40, v60, v2
  v_dot2c_f32_bf16 v40, v61, v3
  v_dot2c_f32_bf16 v40, v62, v4
  v_dot2c_f32_bf16 v40, v63, v5
  v_dot2c_f32_bf16 v40, v64, v6
  v_dot2c_f32_bf16 v40, v65, v7
  v_dot2c_f32_bf16 v40, v66, v8
  v_dot2c_f32_bf16 v40, v67, v9
  v_dot2c_f32_bf16 v40, v68, v10
  v_dot2c_f32_bf16 v40, v69, v11
  v_dot2c_f32_bf16 v40, v70, v12
  v_dot2c_f32_bf16 v40, v71, v13
  s_nop 2
  v_add_f32_dpp v40, v40, v40 quad_perm:[1,0,3,2] row_mask:0xf bank_mask:0xf
  s_nop 1
  v_add_f32_dpp v40, v40, v40 quad_perm:[2,3,0,1] row_mask:0xf bank_mask:0xf
  s_nop 1
  v_add_f32_dpp v40, v40, v40 row_half_mirror row_mask:0xf bank_mask:0xf
  v_cvt_pk_bf16_f32 v40, 0, v40
  v_mul_f32 v40, s55, v40
  v_cvt_pk_bf16_f32 v40, 0, v40
  v_mul_f32 v253, s56, v40
  v_max_f32 v39, v39, v253
  s_cmp_eq_u32 s15, 1
  s_cselect_b32 s64, s44, s40
  s_cselect_b32 s65, s45, s41
  s_cselect_b32 s8, s9, s8
  s_bfe_u32 s100, s8, 0x10005
  s_bfe_u32 s101, s8, 0x20003
  s_lshl_b32 s101, s101, 1
  s_or_b32 s100, s100, s101
  s_lshl_b32 s100, s100, 3
  s_and_b32 s101, s8, 0xffffffc7
  s_or_b32 s100, s100, s101
  s_add_u32 s52, s100, s7
  s_and_b32 s52, s52, 1023
  s_mul_i32 s52, s52, 3072
  s_waitcnt vmcnt(3)
  buffer_load_dwordx4 v[48:51], v1, s[64:67], s52 offen offset:0 nt
  buffer_load_dwordx4 v[52:55], v1, s[64:67], s52 offen offset:128 nt
  buffer_load_dwordx4 v[56:59], v1, s[64:67], s52 offen offset:256 nt
  s_add_u32 s8, s8, 32
  s_bfe_u32 s100, s8, 0x10005
  s_bfe_u32 s101, s8, 0x20003
  s_lshl_b32 s101, s101, 1
  s_or_b32 s100, s100, s101
  s_lshl_b32 s100, s100, 3
  s_and_b32 s101, s8, 0xffffffc7
  s_or_b32 s100, s100, s101
  s_add_u32 s52, s100, s7
  s_and_b32 s52, s52, 1023
  s_mul_i32 s52, s52, 3072
  v_mov_b32 v40, 0
  v_dot2c_f32_bf16 v40, v72, v2
  v_dot2c_f32_bf16 v40, v73, v3
  v_dot2c_f32_bf16 v40, v74, v4
  v_dot2c_f32_bf16 v40, v75, v5
  v_dot2c_f32_bf16 v40, v76, v6
  v_dot2c_f32_bf16 v40, v77, v7
  v_dot2c_f32_bf16 v40, v78, v8
  v_dot2c_f32_bf16 v40, v79, v9
  v_dot2c_f32_bf16 v40, v80, v10
  v_dot2c_f32_bf16 v40, v81, v11
  v_dot2c_f32_bf16 v40, v82, v12
  v_dot2c_f32_bf16 v40, v83, v13
  s_nop 2
  v_add_f32_dpp v40, v40, v40 quad_perm:[1,0,3,2] row_mask:0xf bank_mask:0xf
  s_nop 1
  v_add_f32_dpp v40, v40, v40 quad_perm:[2,3,0,1] row_mask:0xf bank_mask:0xf
  s_nop 1
  v_add_f32_dpp v40, v40, v40 row_half_mirror row_mask:0xf bank_mask:0xf
  v_cvt_pk_bf16_f32 v40, 0, v40
  v_mul_f32 v40, s55, v40
  v_cvt_pk_bf16_f32 v40, 0, v40
  v_mul_f32 v254, s56, v40
  v_max_f32 v39, v39, v254
  s_waitcnt vmcnt(3)
  buffer_load_dwordx4 v[60:63], v1, s[64:67], s52 offen offset:0 nt
  buffer_load_dwordx4 v[64:67], v1, s[64:67], s52 offen offset:128 nt
  buffer_load_dwordx4 v[68:71], v1, s[64:67], s52 offen offset:256 nt
  s_add_u32 s8, s8, 32
  s_bfe_u32 s100, s8, 0x10005
  s_bfe_u32 s101, s8, 0x20003
  s_lshl_b32 s101, s101, 1
  s_or_b32 s100, s100, s101
  s_lshl_b32 s100, s100, 3
  s_and_b32 s101, s8, 0xffffffc7
  s_or_b32 s100, s100, s101
  s_add_u32 s52, s100, s7
  s_and_b32 s52, s52, 1023
  s_mul_i32 s52, s52, 3072
  v_mov_b32 v40, 0
  v_dot2c_f32_bf16 v40, v84, v2
  v_dot2c_f32_bf16 v40, v85, v3
  v_dot2c_f32_bf16 v40, v86, v4
  v_dot2c_f32_bf16 v40, v87, v5
  v_dot2c_f32_bf16 v40, v88, v6
  v_dot2c_f32_bf16 v40, v89, v7
  v_dot2c_f32_bf16 v40, v90, v8
  v_dot2c_f32_bf16 v40, v91, v9
  v_dot2c_f32_bf16 v40, v92, v10
  v_dot2c_f32_bf16 v40, v93, v11
  v_dot2c_f32_bf16 v40, v94, v12
  v_dot2c_f32_bf16 v40, v95, v13
  s_nop 2
  v_add_f32_dpp v40, v40, v40 quad_perm:[1,0,3,2] row_mask:0xf bank_mask:0xf
  s_nop 1
  v_add_f32_dpp v40, v40, v40 quad_perm:[2,3,0,1] row_mask:0xf bank_mask:0xf
  s_nop 1
  v_add_f32_dpp v40, v40, v40 row_half_mirror row_mask:0xf bank_mask:0xf
  v_cvt_pk_bf16_f32 v40, 0, v40
  v_mul_f32 v40, s55, v40
  v_cvt_pk_bf16_f32 v40, 0, v40
  v_mul_f32 v255, s56, v40
  v_max_f32 v39, v39, v255
  s_sub_u32 s15, s15, 1
  s_cmp_lg_u32 s15, 0
  s_cbranch_scc1 L_kloop
  v_mov_b32 v40, v39
  s_swappc_b64 s[60:61], s[58:59]
  s_mov_b32 s15, 6
  .p2align 3
L_vloop:
  s_waitcnt vmcnt(3)
  buffer_load_dwordx4 v[72:75], v1, s[44:47], s52 offen offset:0 nt
  buffer_load_dwordx4 v[76:79], v1, s[44:47], s52 offen offset:128 nt
  buffer_load_dwordx4 v[80:83], v1, s[44:47], s52 offen offset:256 nt
  s_add_u32 s8, s8, 32
  s_bfe_u32 s100, s8, 0x10005
  s_bfe_u32 s101, s8, 0x20003
  s_lshl_b32 s101, s101, 1
  s_or_b32 s100, s100, s101
  s_lshl_b32 s100, s100, 3
  s_and_b32 s101, s8, 0xffffffc7
  s_or_b32 s100, s100, s101
  s_add_u32 s52, s100, s7
  s_and_b32 s52, s52, 1023
  s_mul_i32 s52, s52, 3072
  v_subrev_f32 v40, s54, v228
  v_exp_f32 v40, v40
  s_nop 0
  v_add_f32 v38, v38, v40
  v_cvt_pk_bf16_f32 v41, v40, 0
  v_cvt_pk_bf16_f32 v42, 0, v40
  v_dot2c_f32_bf16 v14, v48, v41
  v_dot2c_f32_bf16 v15, v48, v42
  v_dot2c_f32_bf16 v16, v49, v41
  v_dot2c_f32_bf16 v17, v49, v42
  v_dot2c_f32_bf16 v18, v50, v41
  v_dot2c_f32_bf16 v19, v50, v42
  v_dot2c_f32_bf16 v20, v51, v41
  v_dot2c_f32_bf16 v21, v51, v42
  v_dot2c_f32_bf16 v22, v52, v41
  v_dot2c_f32_bf16 v23, v52, v42
  v_dot2c_f32_bf16 v24, v53, v41
  v_dot2c_f32_bf16 v25, v53, v42
  v_dot2c_f32_bf16 v26, v54, v41
  v_dot2c_f32_bf16 v27, v54, v42
  v_dot2c_f32_bf16 v28, v55, v41
  v_dot2c_f32_bf16 v29, v55, v42
  v_dot2c_f32_bf16 v30, v56, v41
  v_dot2c_f32_bf16 v31, v56, v42
  v_dot2c_f32_bf16 v32, v57, v41
  v_dot2c_f32_bf16 v33, v57, v42
  v_dot2c_f32_bf16 v34, v58, v41
  v_dot2c_f32_bf16 v35, v58, v42
  v_dot2c_f32_bf16 v36, v59, v41
  v_dot2c_f32_bf16 v37, v59, v42
  s_waitcnt vmcnt(3)
  buffer_load_dwordx4 v[84:87], v1, s[44:47], s52 offen offset:0 nt
  buffer_load_dwordx4 v[88:91], v1, s[44:47], s52 offen offset:128 nt
  buffer_load_dwordx4 v[92:95], v1, s[44:47], s52 offen offset:256 nt
  s_add_u32 s8, s8, 32
  s_bfe_u32 s100, s8, 0x10005
  s_bfe_u32 s101, s8, 0x20003
  s_lshl_b32 s101, s101, 1
  s_or_b32 s100, s100, s101
  s_lshl_b32 s100, s100, 3
  s_and_b32 s101, s8, 0xffffffc7
  s_or_b32 s100, s100, s101
  s_add_u32 s52, s100, s7
  s_and_b32 s52, s52, 1023
  s_mul_i32 s52, s52, 3072
  v_subrev_f32 v40, s54, v229
  v_exp_f32 v40, v40
  s_nop 0
  v_add_f32 v38, v38, v40
  v_cvt_pk_bf16_f32 v41, v40, 0
  v_cvt_pk_bf16_f32 v42, 0, v40
  v_dot2c_f32_bf16 v14, v60, v41
  v_dot2c_f32_bf16 v15, v60, v42
  v_dot2c_f32_bf16 v16, v61, v41
  v_dot2c_f32_bf16 v17, v61, v42
  v_dot2c_f32_bf16 v18, v62, v41
  v_dot2c_f32_bf16 v19, v62, v42
  v_dot2c_f32_bf16 v20, v63, v41
  v_dot2c_f32_bf16 v21, v63, v42
  v_dot2c_f32_bf16 v22, v64, v41
  v_dot2c_f32_bf16 v23, v64, v42
  v_dot2c_f32_bf16 v24, v65, v41
  v_dot2c_f32_bf16 v25, v65, v42
  v_dot2c_f32_bf16 v26, v66, v41
  v_dot2c_f32_bf16 v27, v66, v42
  v_dot2c_f32_bf16 v28, v67, v41
  v_dot2c_f32_bf16 v29, v67, v42
  v_dot2c_f32_bf16 v30, v68, v41
  v_dot2c_f32_bf16 v31, v68, v42
  v_dot2c_f32_bf16 v32, v69, v41
  v_dot2c_f32_bf16 v33, v69, v42
  v_dot2c_f32_bf16 v34, v70, v41
  v_dot2c_f32_bf16 v35, v70, v42
  v_dot2c_f32_bf16 v36, v71, v41
  v_dot2c_f32_bf16 v37, v71, v42
  s_waitcnt vmcnt(3)
  buffer_load_dwordx4 v[48:51], v1, s[44:47], s52 offen offset:0 nt
  buffer_load_dwordx4 v[52:55], v1, s[44:47], s52 offen offset:128 nt
  buffer_load_dwordx4 v[56:59], v1, s[44:47], s52 offen offset:256 nt
  s_add_u32 s8, s8, 32
  s_bfe_u32 s100, s8, 0x10005
  s_bfe_u32 s101, s8, 0x20003
  s_lshl_b32 s101, s101, 1
  s_or_b32 s100, s100, s101
  s_lshl_b32 s100, s100, 3
  s_and_b32 s101, s8, 0xffffffc7
  s_or_b32 s100, s100, s101
  s_add_u32 s52, s100, s7
  s_and_b32 s52, s52, 1023
  s_mul_i32 s52, s52, 3072
  v_subrev_f32 v40, s54, v230
  v_exp_f32 v40, v40
  s_nop 0
  v_add_f32 v38, v38, v40
  v_cvt_pk_bf16_f32 v41, v40, 0
  v_cvt_pk_bf16_f32 v42, 0, v40
  v_dot2c_f32_bf16 v14, v72, v41
  v_dot2c_f32_bf16 v15, v72, v42
  v_dot2c_f32_bf16 v16, v73, v41
  v_dot2c_f32_bf16 v17, v73, v42
  v_dot2c_f32_bf16 v18, v74, v41
  v_dot2c_f32_bf16 v19, v74, v42
  v_dot2c_f32_bf16 v20, v75, v41
  v_dot2c_f32_bf16 v21, v75, v42
  v_dot2c_f32_bf16 v22, v76, v41
  v_dot2c_f32_bf16 v23, v76, v42
  v_dot2c_f32_bf16 v24, v77, v41
  v_dot2c_f32_bf16 v25, v77, v42
  v_dot2c_f32_bf16 v26, v78, v41
  v_dot2c_f32_bf16 v27, v78, v42
  v_dot2c_f32_bf16 v28, v79, v41
  v_dot2c_f32_bf16 v29, v79, v42
  v_dot2c_f32_bf16 v30, v80, v41
  v_dot2c_f32_bf16 v31, v80, v42
  v_dot2c_f32_bf16 v32, v81, v41
  v_dot2c_f32_bf16 v33, v81, v42
  v_dot2c_f32_bf16 v34, v82, v41
  v_dot2c_f32_bf16 v35, v82, v42
  v_dot2c_f32_bf16 v36, v83, v41
  v_dot2c_f32_bf16 v37, v83, v42
  s_waitcnt vmcnt(3)
  buffer_load_dwordx4 v[60:63], v1, s[44:47], s52 offen offset:0 nt
  buffer_load_dwordx4 v[64:67], v1, s[44:47], s52 offen offset:128 nt
  buffer_load_dwordx4 v[68:71], v1, s[44:47], s52 offen offset:256 nt
  s_add_u32 s8, s8, 32
  s_bfe_u32 s100, s8, 0x10005
  s_bfe_u32 s101, s8, 0x20003
  s_lshl_b32 s101, s101, 1
  s_or_b32 s100, s100, s101
  s_lshl_b32 s100, s100, 3
  s_and_b32 s101, s8, 0xffffffc7
  s_or_b32 s100, s100, s101
  s_add_u32 s52, s100, s7
  s_and_b32 s52, s52, 1023
  s_mul_i32 s52, s52, 3072
  v_subrev_f32 v40, s54, v231
  v_exp_f32 v40, v40
  s_nop 0
  v_add_f32 v38, v38, v40
  v_cvt_pk_bf16_f32 v41, v40, 0
  v_cvt_pk_bf16_f32 v42, 0, v40
  v_dot2c_f32_bf16 v14, v84, v41
  v_dot2c_f32_bf16 v15, v84, v42
  v_dot2c_f32_bf16 v16, v85, v41
  v_dot2c_f32_bf16 v17, v85, v42
  v_dot2c_f32_bf16 v18, v86, v41
  v_dot2c_f32_bf16 v19, v86, v42
  v_dot2c_f32_bf16 v20, v87, v41
  v_dot2c_f32_bf16 v21, v87, v42
  v_dot2c_f32_bf16 v22, v88, v41
  v_dot2c_f32_bf16 v23, v88, v42
  v_dot2c_f32_bf16 v24, v89, v41
  v_dot2c_f32_bf16 v25, v89, v42
  v_dot2c_f32_bf16 v26, v90, v41
  v_dot2c_f32_bf16 v27, v90, v42
  v_dot2c_f32_bf16 v28, v91, v41
  v_dot2c_f32_bf16 v29, v91, v42
  v_dot2c_f32_bf16 v30, v92, v41
  v_dot2c_f32_bf16 v31, v92, v42
  v_dot2c_f32_bf16 v32, v93, v41
  v_dot2c_f32_bf16 v33, v93, v42
  v_dot2c_f32_bf16 v34, v94, v41
  v_dot2c_f32_bf16 v35, v94, v42
  v_dot2c_f32_bf16 v36, v95, v41
  v_dot2c_f32_bf16 v37, v95, v42
  v_mov_b32 v228, v232
  v_mov_b32 v229, v233
  v_mov_b32 v230, v234
  v_mov_b32 v231, v235
  v_mov_b32 v232, v236
  v_mov_b32 v233, v237
  v_mov_b32 v234, v238
  v_mov_b32 v235, v239
  v_mov_b32 v236, v240
  v_mov_b32 v237, v241
  v_mov_b32 v238, v242
  v_mov_b32 v239, v243
  v_mov_b32 v240, v244
  v_mov_b32 v241, v245
  v_mov_b32 v242, v246
  v_mov_b32 v243, v247
  v_mov_b32 v244, v248
  v_mov_b32 v245, v249
  v_mov_b32 v246, v250
  v_mov_b32 v247, v251
  v_mov_b32 v248, v252
  v_mov_b32 v249, v253
  v_mov_b32 v250, v254
  v_mov_b32 v251, v255
  s_sub_u32 s15, s15, 1
  s_cmp_lg_u32 s15, 0
  s_cbranch_scc1 L_vloop
  s_waitcnt vmcnt(3)
  buffer_load_dwordx4 v[72:75], v1, s[44:47], s52 offen offset:0 nt
  buffer_load_dwordx4 v[76:79], v1, s[44:47], s52 offen offset:128 nt
  buffer_load_dwordx4 v[80:83], v1, s[44:47], s52 offen offset:256 nt
  s_add_u32 s8, s8, 32
  s_bfe_u32 s100, s8, 0x10005
  s_bfe_u32 s101, s8, 0x20003
  s_lshl_b32 s101, s101, 1
  s_or_b32 s100, s100, s101
  s_lshl_b32 s100, s100, 3
  s_and_b32 s101, s8, 0xffffffc7
  s_or_b32 s100, s100, s101
  s_add_u32 s52, s100, s7
  s_and_b32 s52, s52, 1023
  s_mul_i32 s52, s52, 3072
  v_subrev_f32 v40, s54, v228
  v_exp_f32 v40, v40
  s_nop 0
  v_add_f32 v38, v38, v40
  v_cvt_pk_bf16_f32 v41, v40, 0
  v_cvt_pk_bf16_f32 v42, 0, v40
  v_dot2c_f32_bf16 v14, v48, v41
  v_dot2c_f32_bf16 v15, v48, v42
  v_dot2c_f32_bf16 v16, v49, v41
  v_dot2c_f32_bf16 v17, v49, v42
  v_dot2c_f32_bf16 v18, v50, v41
  v_dot2c_f32_bf16 v19, v50, v42
  v_dot2c_f32_bf16 v20, v51, v41
  v_dot2c_f32_bf16 v21, v51, v42
  v_dot2c_f32_bf16 v22, v52, v41
  v_dot2c_f32_bf16 v23, v52, v42
  v_dot2c_f32_bf16 v24, v53, v41
  v_dot2c_f32_bf16 v25, v53, v42
  v_dot2c_f32_bf16 v26, v54, v41
  v_dot2c_f32_bf16 v27, v54, v42
  v_dot2c_f32_bf16 v28, v55, v41
  v_dot2c_f32_bf16 v29, v55, v42
  v_dot2c_f32_bf16 v30, v56, v41
  v_dot2c_f32_bf16 v31, v56, v42
  v_dot2c_f32_bf16 v32, v57, v41
  v_dot2c_f32_bf16 v33, v57, v42
  v_dot2c_f32_bf16 v34, v58, v41
  v_dot2c_f32_bf16 v35, v58, v42
  v_dot2c_f32_bf16 v36, v59, v41
  v_dot2c_f32_bf16 v37, v59, v42
  s_waitcnt vmcnt(3)
  buffer_load_dwordx4 v[84:87], v1, s[44:47], s52 offen offset:0 nt
  buffer_load_dwordx4 v[88:91], v1, s[44:47], s52 offen offset:128 nt
  buffer_load_dwordx4 v[92:95], v1, s[44:47], s52 offen offset:256 nt
  s_add_u32 s8, s8, 32
  s_bfe_u32 s100, s8, 0x10005
  s_bfe_u32 s101, s8, 0x20003
  s_lshl_b32 s101, s101, 1
  s_or_b32 s100, s100, s101
  s_lshl_b32 s100, s100, 3
  s_and_b32 s101, s8, 0xffffffc7
  s_or_b32 s100, s100, s101
  s_add_u32 s52, s100, s7
  s_and_b32 s52, s52, 1023
  s_mul_i32 s52, s52, 3072
  v_subrev_f32 v40, s54, v229
  v_exp_f32 v40, v40
  s_nop 0
  v_add_f32 v38, v38, v40
  v_cvt_pk_bf16_f32 v41, v40, 0
  v_cvt_pk_bf16_f32 v42, 0, v40
  v_dot2c_f32_bf16 v14, v60, v41
  v_dot2c_f32_bf16 v15, v60, v42
  v_dot2c_f32_bf16 v16, v61, v41
  v_dot2c_f32_bf16 v17, v61, v42
  v_dot2c_f32_bf16 v18, v62, v41
  v_dot2c_f32_bf16 v19, v62, v42
  v_dot2c_f32_bf16 v20, v63, v41
  v_dot2c_f32_bf16 v21, v63, v42
  v_dot2c_f32_bf16 v22, v64, v41
  v_dot2c_f32_bf16 v23, v64, v42
  v_dot2c_f32_bf16 v24, v65, v41
  v_dot2c_f32_bf16 v25, v65, v42
  v_dot2c_f32_bf16 v26, v66, v41
  v_dot2c_f32_bf16 v27, v66, v42
  v_dot2c_f32_bf16 v28, v67, v41
  v_dot2c_f32_bf16 v29, v67, v42
  v_dot2c_f32_bf16 v30, v68, v41
  v_dot2c_f32_bf16 v31, v68, v42
  v_dot2c_f32_bf16 v32, v69, v41
  v_dot2c_f32_bf16 v33, v69, v42
  v_dot2c_f32_bf16 v34, v70, v41
  v_dot2c_f32_bf16 v35, v70, v42
  v_dot2c_f32_bf16 v36, v71, v41
  v_dot2c_f32_bf16 v37, v71, v42
  s_mov_b32 s12, 1
  s_atomic_add s12, s[10:11], 0x0 glc
  s_waitcnt vmcnt(3)
  buffer_load_dwordx4 v[48:51], v1, s[40:43], s52 offen offset:0 nt
  buffer_load_dwordx4 v[52:55], v1, s[40:43], s52 offen offset:128 nt
  buffer_load_dwordx4 v[56:59], v1, s[40:43], s52 offen offset:256 nt
  v_subrev_f32 v40, s54, v230
  v_exp_f32 v40, v40
  s_nop 0
  v_add_f32 v38, v38, v40
  v_cvt_pk_bf16_f32 v41, v40, 0
  v_cvt_pk_bf16_f32 v42, 0, v40
  v_dot2c_f32_bf16 v14, v72, v41
  v_dot2c_f32_bf16 v15, v72, v42
  v_dot2c_f32_bf16 v16, v73, v41
  v_dot2c_f32_bf16 v17, v73, v42
  v_dot2c_f32_bf16 v18, v74, v41
  v_dot2c_f32_bf16 v19, v74, v42
  v_dot2c_f32_bf16 v20, v75, v41
  v_dot2c_f32_bf16 v21, v75, v42
  v_dot2c_f32_bf16 v22, v76, v41
  v_dot2c_f32_bf16 v23, v76, v42
  v_dot2c_f32_bf16 v24, v77, v41
  v_dot2c_f32_bf16 v25, v77, v42
  v_dot2c_f32_bf16 v26, v78, v41
  v_dot2c_f32_bf16 v27, v78, v42
  v_dot2c_f32_bf16 v28, v79, v41
  v_dot2c_f32_bf16 v29, v79, v42
  v_dot2c_f32_bf16 v30, v80, v41
  v_dot2c_f32_bf16 v31, v80, v42
  v_dot2c_f32_bf16 v32, v81, v41
  v_dot2c_f32_bf16 v33, v81, v42
  v_dot2c_f32_bf16 v34, v82, v41
  v_dot2c_f32_bf16 v35, v82, v42
  v_dot2c_f32_bf16 v36, v83, v41
  v_dot2c_f32_bf16 v37, v83, v42
  s_waitcnt vmcnt(3)
  buffer_load_dwordx4 v[60:63], v1, s[44:47], s52 offen offset:0 nt
  buffer_load_dwordx4 v[64:67], v1, s[44:47], s52 offen offset:128 nt
  buffer_load_dwordx4 v[68:71], v1, s[44:47], s52 offen offset:256 nt
  v_subrev_f32 v40, s54, v231
  v_exp_f32 v40, v40
  s_nop 0
  v_add_f32 v38, v38, v40
  v_cvt_pk_bf16_f32 v41, v40, 0
  v_cvt_pk_bf16_f32 v42, 0, v40
  v_dot2c_f32_bf16 v14, v84, v41
  v_dot2c_f32_bf16 v15, v84, v42
  v_dot2c_f32_bf16 v16, v85, v41
  v_dot2c_f32_bf16 v17, v85, v42
  v_dot2c_f32_bf16 v18, v86, v41
  v_dot2c_f32_bf16 v19, v86, v42
  v_dot2c_f32_bf16 v20, v87, v41
  v_dot2c_f32_bf16 v21, v87, v42
  v_dot2c_f32_bf16 v22, v88, v41
  v_dot2c_f32_bf16 v23, v88, v42
  v_dot2c_f32_bf16 v24, v89, v41
  v_dot2c_f32_bf16 v25, v89, v42
  v_dot2c_f32_bf16 v26, v90, v41
  v_dot2c_f32_bf16 v27, v90, v42
  v_dot2c_f32_bf16 v28, v91, v41
  v_dot2c_f32_bf16 v29, v91, v42
  v_dot2c_f32_bf16 v30, v92, v41
  v_dot2c_f32_bf16 v31, v92, v42
  v_dot2c_f32_bf16 v32, v93, v41
  v_dot2c_f32_bf16 v33, v93, v42
  v_dot2c_f32_bf16 v34, v94, v41
  v_dot2c_f32_bf16 v35, v94, v42
  v_dot2c_f32_bf16 v36, v95, v41
  v_dot2c_f32_bf16 v37, v95, v42
  s_setprio 2
  s_lshl_b32 s5, s3, 10
  v_lshrrev_b32 v128, 3, v0
  v_lshlrev_b32 v128, 2, v128
  v_lshl_add_u32 v128, v44, 1, v128
  v_add_u32 v128, s5, v128
  v_mov_b32 v129, s5
  v_lshlrev_b32 v130, 4, v0
  v_lshlrev_b32 v131, 3, v0
  s_lshl_b32 s6, s2, 9
  s_add_u32 s6, s6, 65536
  s_mov_b32 s62, 0
  s_mov_b32 s63, 0x80000000
  s_branch L_l2s0
  .p2align 12
L_loop2:
L_l2s0:
  s_cmp_ge_u32 s52, 3145728
  s_cbranch_scc1 L_ex0
L_re0:
  s_waitcnt vmcnt(3)
  s_waitcnt lgkmcnt(0)
L_tka0:
  s_mov_b32 s8, s12
  s_bfe_u32 s100, s8, 0x10005
  s_bfe_u32 s101, s8, 0x20003
  s_lshl_b32 s101, s101, 1
  s_or_b32 s100, s100, s101
  s_lshl_b32 s100, s100, 3
  s_and_b32 s101, s8, 0xffffffc7
  s_or_b32 s100, s100, s101
  s_add_u32 s53, s100, s7
  s_and_b32 s53, s53, 1023
  s_mul_i32 s53, s53, 3072
  s_cmp_lt_u32 s8, 1024
  s_cbranch_scc1 L_tga0
  s_mov_b32 s53, 3145728
  s_mov_b64 exec, 1
  ds_add_u32 v45, v46
  s_mov_b64 exec, -1
  s_branch L_sta0
L_tga0:
  s_mov_b32 s12, 1
  s_atomic_add s12, s[10:11], 0x0 glc
L_sta0:
  buffer_load_dwordx4 v[72:75], v1, s[40:43], s53 offen offset:0 nt
  buffer_load_dwordx4 v[76:79], v1, s[40:43], s53 offen offset:128 nt
  buffer_load_dwordx4 v[80:83], v1, s[40:43], s53 offen offset:256 nt
  v_mov_b32 v40, 0
  v_dot2c_f32_bf16 v40, v48, v2
  v_dot2c_f32_bf16 v40, v49, v3
  v_dot2c_f32_bf16 v40, v50, v4
  v_dot2c_f32_bf16 v40, v51, v5
  v_dot2c_f32_bf16 v40, v52, v6
  v_dot2c_f32_bf16 v40, v53, v7
  v_dot2c_f32_bf16 v40, v54, v8
  v_dot2c_f32_bf16 v40, v55, v9
  v_dot2c_f32_bf16 v40, v56, v10
  v_dot2c_f32_bf16 v40, v57, v11
  v_dot2c_f32_bf16 v40, v58, v12
  v_dot2c_f32_bf16 v40, v59, v13
  s_nop 2
  v_add_f32_dpp v40, v40, v40 quad_perm:[1,0,3,2] row_mask:0xf bank_mask:0xf
  s_nop 1
  v_add_f32_dpp v40, v40, v40 quad_perm:[2,3,0,1] row_mask:0xf bank_mask:0xf
  s_nop 1
  v_add_f32_dpp v40, v40, v40 row_half_mirror row_mask:0xf bank_mask:0xf
  v_cvt_pk_bf16_f32 v40, 0, v40
  v_mul_f32 v40, s55, v40
  v_cvt_pk_bf16_f32 v40, 0, v40
  v_mul_f32 v40, s56, v40
  v_cmp_lt_f32 vcc, s54, v40
  s_cbranch_vccz L_nr1
  s_swappc_b64 s[60:61], s[58:59]
L_nr1:
  v_subrev_f32 v40, s54, v40
  v_exp_f32 v40, v40
  s_nop 0
  v_add_f32 v38, v38, v40
  v_cvt_pk_bf16_f32 v41, v40, 0
  v_cvt_pk_bf16_f32 v42, 0, v40
  s_waitcnt vmcnt(3)
  buffer_load_dwordx4 v[84:87], v1, s[44:47], s53 offen offset:0 nt
  buffer_load_dwordx4 v[88:91], v1, s[44:47], s53 offen offset:128 nt
  buffer_load_dwordx4 v[92:95], v1, s[44:47], s53 offen offset:256 nt
  v_dot2c_f32_bf16 v14, v60, v41
  v_dot2c_f32_bf16 v15, v60, v42
  v_dot2c_f32_bf16 v16, v61, v41
  v_dot2c_f32_bf16 v17, v61, v42
  v_dot2c_f32_bf16 v18, v62, v41
  v_dot2c_f32_bf16 v19, v62, v42
  v_dot2c_f32_bf16 v20, v63, v41
  v_dot2c_f32_bf16 v21, v63, v42
  v_dot2c_f32_bf16 v22, v64, v41
  v_dot2c_f32_bf16 v23, v64, v42
  v_dot2c_f32_bf16 v24, v65, v41
  v_dot2c_f32_bf16 v25, v65, v42
  v_dot2c_f32_bf16 v26, v66, v41
  v_dot2c_f32_bf16 v27, v66, v42
  v_dot2c_f32_bf16 v28, v67, v41
  v_dot2c_f32_bf16 v29, v67, v42
  v_dot2c_f32_bf16 v30, v68, v41
  v_dot2c_f32_bf16 v31, v68, v42
  v_dot2c_f32_bf16 v32, v69, v41
  v_dot2c_f32_bf16 v33, v69, v42
  v_dot2c_f32_bf16 v34, v70, v41
  v_dot2c_f32_bf16 v35, v70, v42
  v_dot2c_f32_bf16 v36, v71, v41
  v_dot2c_f32_bf16 v37, v71, v42
L_l2s1:
  s_cmp_ge_u32 s53, 3145728
  s_cbranch_scc1 L_ex1
L_re1:
  s_waitcnt vmcnt(3)
  s_waitcnt lgkmcnt(0)
L_tka1:
  s_mov_b32 s8, s12
  s_bfe_u32 s100, s8, 0x10005
  s_bfe_u32 s101, s8, 0x20003
  s_lshl_b32 s101, s101, 1
  s_or_b32 s100, s100, s101
  s_lshl_b32 s100, s100, 3
  s_and_b32 s101, s8, 0xffffffc7
  s_or_b32 s100, s100, s101
  s_add_u32 s52, s100, s7
  s_and_b32 s52, s52, 1023
  s_mul_i32 s52, s52, 3072
  s_cmp_lt_u32 s8, 1024
  s_cbranch_scc1 L_tga1
  s_mov_b32 s52, 3145728
  s_mov_b64 exec, 1
  ds_add_u32 v45, v46
  s_mov_b64 exec, -1
  s_branch L_sta1
L_tga1:
  s_mov_b32 s12, 1
  s_atomic_add s12, s[10:11], 0x0 glc
L_sta1:
  buffer_load_dwordx4 v[48:51], v1, s[40:43], s52 offen offset:0 nt
  buffer_load_dwordx4 v[52:55], v1, s[40:43], s52 offen offset:128 nt
  buffer_load_dwordx4 v[56:59], v1, s[40:43], s52 offen offset:256 nt
  v_mov_b32 v40, 0
  v_dot2c_f32_bf16 v40, v72, v2
  v_dot2c_f32_bf16 v40, v73, v3
  v_dot2c_f32_bf16 v40, v74, v4
  v_dot2c_f32_bf16 v40, v75, v5
  v_dot2c_f32_bf16 v40, v76, v6
  v_dot2c_f32_bf16 v40, v77, v7
  v_dot2c_f32_bf16 v40, v78, v8
  v_dot2c_f32_bf16 v40, v79, v9
  v_dot2c_f32_bf16 v40, v80, v10
  v_dot2c_f32_bf16 v40, v81, v11
  v_dot2c_f32_bf16 v40, v82, v12
  v_dot2c_f32_bf16 v40, v83, v13
  s_nop 2
  v_add_f32_dpp v40, v40, v40 quad_perm:[1,0,3,2] row_mask:0xf bank_mask:0xf
  s_nop 1
  v_add_f32_dpp v40, v40, v40 quad_perm:[2,3,0,1] row_mask:0xf bank_mask:0xf
  s_nop 1
  v_add_f32_dpp v40, v40, v40 row_half_mirror row_mask:0xf bank_mask:0xf
  v_cvt_pk_bf16_f32 v40, 0, v40
  v_mul_f32 v40, s55, v40
  v_cvt_pk_bf16_f32 v40, 0, v40
  v_mul_f32 v40, s56, v40
  v_cmp_lt_f32 vcc, s54, v40
  s_cbranch_vccz L_nr2
  s_swappc_b64 s[60:61], s[58:59]
L_nr2:
  v_subrev_f32 v40, s54, v40
  v_exp_f32 v40, v40
  s_nop 0
  v_add_f32 v38, v38, v40
  v_cvt_pk_bf16_f32 v41, v40, 0
  v_cvt_pk_bf16_f32 v42, 0, v40
  s_waitcnt vmcnt(3)
  buffer_load_dwordx4 v[60:63], v1, s[44:47], s52 offen offset:0 nt
  buffer_load_dwordx4 v[64:67], v1, s[44:47], s52 offen offset:128 nt
  buffer_load_dwordx4 v[68:71], v1, s[44:47], s52 offen offset:256 nt
  v_dot2c_f32_bf16 v14, v84, v41
  v_dot2c_f32_bf16 v15, v84, v42
  v_dot2c_f32_bf16 v16, v85, v41
  v_dot2c_f32_bf16 v17, v85, v42
  v_dot2c_f32_bf16 v18, v86, v41
  v_dot2c_f32_bf16 v19, v86, v42
  v_dot2c_f32_bf16 v20, v87, v41
  v_dot2c_f32_bf16 v21, v87, v42
  v_dot2c_f32_bf16 v22, v88, v41
  v_dot2c_f32_bf16 v23, v88, v42
  v_dot2c_f32_bf16 v24, v89, v41
  v_dot2c_f32_bf16 v25, v89, v42
  v_dot2c_f32_bf16 v26, v90, v41
  v_dot2c_f32_bf16 v27, v90, v42
  v_dot2c_f32_bf16 v28, v91, v41
  v_dot2c_f32_bf16 v29, v91, v42
  v_dot2c_f32_bf16 v30, v92, v41
  v_dot2c_f32_bf16 v31, v92, v42
  v_dot2c_f32_bf16 v32, v93, v41
  v_dot2c_f32_bf16 v33, v93, v42
  v_dot2c_f32_bf16 v34, v94, v41
  v_dot2c_f32_bf16 v35, v94, v42
  v_dot2c_f32_bf16 v36, v95, v41
  v_dot2c_f32_bf16 v37, v95, v42
  s_branch L_loop2
L_ex0:
L_ex1:
L_ldone:
  v_add_f32_dpp v38, v38, v38 row_ror:8 row_mask:0xf bank_mask:0xf
  v_mov_b32 v39, s54
  s_nop 0
  v_add_f32_dpp v38, v38, v38 row_bcast:15 row_mask:0xa bank_mask:0xf
  v_permlane32_swap_b32 v14, v18
  v_permlane32_swap_b32 v15, v19
  v_permlane32_swap_b32 v16, v20
  v_permlane32_swap_b32 v17, v21
  v_permlane32_swap_b32 v22, v26
  v_permlane32_swap_b32 v23, v27
  v_permlane32_swap_b32 v24, v28
  v_permlane32_swap_b32 v25, v29
  v_permlane32_swap_b32 v30, v34
  v_permlane32_swap_b32 v31, v35
  v_permlane32_swap_b32 v32, v36
  v_permlane32_swap_b32 v33, v37
  v_pk_add_f32 v[14:15], v[14:15], v[18:19]
  v_pk_add_f32 v[16:17], v[16:17], v[20:21]
  v_pk_add_f32 v[22:23], v[22:23], v[26:27]
  v_pk_add_f32 v[24:25], v[24:25], v[28:29]
  v_pk_add_f32 v[30:31], v[30:31], v[34:35]
  v_pk_add_f32 v[32:33], v[32:33], v[36:37]
  v_permlane16_swap_b32 v14, v16
  v_permlane16_swap_b32 v15, v17
  v_permlane16_swap_b32 v22, v24
  v_permlane16_swap_b32 v23, v25
  v_permlane16_swap_b32 v30, v32
  v_permlane16_swap_b32 v31, v33
  v_pk_add_f32 v[14:15], v[14:15], v[16:17]
  v_pk_add_f32 v[22:23], v[22:23], v[24:25]
  v_pk_add_f32 v[30:31], v[30:31], v[32:33]
  v_add_f32_dpp v16, v14, v14 row_ror:8 row_mask:0xf bank_mask:0x3
  v_add_f32_dpp v24, v22, v22 row_ror:8 row_mask:0xf bank_mask:0x3
  v_add_f32_dpp v32, v30, v30 row_ror:8 row_mask:0xf bank_mask:0x3
  v_add_f32_dpp v16, v15, v15 row_ror:8 row_mask:0xf bank_mask:0xc
  v_add_f32_dpp v24, v23, v23 row_ror:8 row_mask:0xf bank_mask:0xc
  v_add_f32_dpp v32, v31, v31 row_ror:8 row_mask:0xf bank_mask:0xc
  v_add_f32_dpp v38, v38, v38 row_bcast:31 row_mask:0xc bank_mask:0xf
  ds_write_b32 v128, v16 offset:1024
  ds_write_b32 v128, v24 offset:1280
  ds_write_b32 v128, v32 offset:1536
  s_mov_b64 exec, s[62:63]
  ds_write_b64 v129, v[38:39] offset:1792
  ds_add_rtn_u32 v47, v45, v46 offset:4
  s_mov_b64 exec, -1
  ds_read_b64 v[96:97], v45 offset:1280
  ds_read_b64 v[98:99], v45 offset:2304
  ds_read_b64 v[100:101], v45 offset:3328
  ds_read_b64 v[102:103], v45 offset:4352
  ds_read_b128 v[104:107], v130 offset:1024
  ds_read_b128 v[108:111], v130 offset:2048
  ds_read_b128 v[112:115], v130 offset:3072
  ds_read_b128 v[116:119], v130 offset:4096
  s_waitcnt lgkmcnt(4)
  v_readlane_b32 s5, v47, 63
  v_max3_f32 v121, v97, v99, v101
  v_max_f32 v121, v121, v103
  s_cmp_lg_u32 s5, 3
  s_cbranch_scc1 L_sdone
  v_sub_f32 v97, v97, v121
  v_sub_f32 v99, v99, v121
  v_sub_f32 v101, v101, v121
  v_sub_f32 v103, v103, v121
  v_exp_f32 v97, v97
  v_exp_f32 v99, v99
  v_exp_f32 v101, v101
  v_exp_f32 v103, v103
  s_waitcnt lgkmcnt(0)
  v_pk_mul_f32 v[104:105], v[104:105], v[96:97] op_sel:[0,1] op_sel_hi:[1,1]
  v_pk_mul_f32 v[106:107], v[106:107], v[96:97] op_sel:[0,1] op_sel_hi:[1,1]
  v_mul_f32 v120, v96, v97
  v_pk_fma_f32 v[104:105], v[108:109], v[98:99], v[104:105] op_sel:[0,1,0] op_sel_hi:[1,1,1]
  v_pk_fma_f32 v[106:107], v[110:111], v[98:99], v[106:107] op_sel:[0,1,0] op_sel_hi:[1,1,1]
  v_fmac_f32 v120, v98, v99
  v_pk_fma_f32 v[104:105], v[112:113], v[100:101], v[104:105] op_sel:[0,1,0] op_sel_hi:[1,1,1]
  v_pk_fma_f32 v[106:107], v[114:115], v[100:101], v[106:107] op_sel:[0,1,0] op_sel_hi:[1,1,1]
  v_fmac_f32 v120, v100, v101
  v_pk_fma_f32 v[104:105], v[116:117], v[102:103], v[104:105] op_sel:[0,1,0] op_sel_hi:[1,1,1]
  v_pk_fma_f32 v[106:107], v[118:119], v[102:103], v[106:107] op_sel:[0,1,0] op_sel_hi:[1,1,1]
  v_fmac_f32 v120, v102, v103
  s_mov_b32 exec_hi, 0xffff
  v_cvt_pk_bf16_f32 v120, v104, v105
  v_cvt_pk_bf16_f32 v121, v106, v107
  s_mov_b32 exec_hi, 0x3ffff
  buffer_store_dwordx2 v[120:121], v131, s[48:51], s6 offen sc1
  ds_write_b32 v45, v46 offset:24
L_sdone:
  s_endpgm
L_rescale:
  v_mov_b32 v41, v40
  v_mov_b32 v42, s54
  s_nop 0
  v_max_f32_dpp v41, v41, v41 row_ror:8 row_mask:0xf bank_mask:0xf
  s_nop 1
  v_max_f32_dpp v41, v41, v41 row_bcast:15 row_mask:0xa bank_mask:0xf
  s_nop 1
  v_max_f32_dpp v41, v41, v41 row_bcast:31 row_mask:0xc bank_mask:0xf
  s_nop 0
  v_readlane_b32 s54, v41, 63
  s_nop 1
  v_subrev_f32 v42, s54, v42
  v_exp_f32 v42, v42
  s_nop 0
  v_mul_f32 v14, v14, v42
  v_mul_f32 v15, v15, v42
  v_mul_f32 v16, v16, v42
  v_mul_f32 v17, v17, v42
  v_mul_f32 v18, v18, v42
  v_mul_f32 v19, v19, v42
  v_mul_f32 v20, v20, v42
  v_mul_f32 v21, v21, v42
  v_mul_f32 v22, v22, v42
  v_mul_f32 v23, v23, v42
  v_mul_f32 v24, v24, v42
  v_mul_f32 v25, v25, v42
  v_mul_f32 v26, v26, v42
  v_mul_f32 v27, v27, v42
  v_mul_f32 v28, v28, v42
  v_mul_f32 v29, v29, v42
  v_mul_f32 v30, v30, v42
  v_mul_f32 v31, v31, v42
  v_mul_f32 v32, v32, v42
  v_mul_f32 v33, v33, v42
  v_mul_f32 v34, v34, v42
  v_mul_f32 v35, v35, v42
  v_mul_f32 v36, v36, v42
  v_mul_f32 v37, v37, v42
  v_mul_f32 v38, v38, v42
  s_setpc_b64 s[60:61]
  .p2align 12
L_service:
  s_setprio 3
  v_mov_b32 v60, 0
  v_mov_b32 v61, 0
  v_mov_b32 v62, 0
  v_mov_b32 v63, 0
  ds_write_b128 v62, v[60:63] offset:512
  ds_write_b128 v62, v[60:63] offset:528
  s_sub_u32 s4, s3, 4
  s_add_u32 s7, s5, s6
  s_and_b32 s7, s7, 7
  s_sub_u32 s8, s7, 3
  s_sub_u32 s9, s7, 2
  s_cmp_ge_u32 s9, 3
  s_cselect_b32 s12, 3931776, 0
  s_cselect_b32 s15, 640, 0
  s_mul_i32 s11, s6, 384
  s_add_u32 s11, s11, s12
  s_lshl_b32 s12, s9, 7
  s_add_u32 s11, s11, s12
  s_mul_i32 s12, s4, 983040
  s_mov_b32 s13, 122880
  v_mul_lo_u32 v3, v1, s13
  v_lshl_add_u32 v3, v2, 4, v3
  v_lshlrev_b32 v9, 2, v0
  v_mul_u32_u24 v10, 20, v1
  s_mul_i32 s13, s4, 160
  s_add_u32 s15, s15, s13
  s_mov_b32 s57, 262144
  s_waitcnt lgkmcnt(0)
  v_mov_b32 v61, 1
  s_load_dword s14, s[38:39], 589824
  s_mov_b32 s40, s16
  s_mov_b32 s41, s17
  s_mov_b32 s42, 1280
  s_mov_b32 s43, 0x20000
  s_mov_b32 s48, s38
  s_mov_b32 s49, s39
  s_mov_b32 s50, 2097152
  s_mov_b32 s51, 0x20000
  s_add_u32 s44, s22, s11
  s_addc_u32 s45, s23, 0
  s_mov_b32 s46, 3920000
  s_mov_b32 s47, 0x20000
  s_cmp_lt_u32 s9, 6
  s_cbranch_scc0 L_noq1
  buffer_load_dword v4, v9, s[40:43], 0 offen offset:0
  buffer_load_dword v5, v9, s[40:43], 0 offen offset:256
  buffer_load_dword v6, v9, s[40:43], 0 offen offset:512
  buffer_load_dword v7, v9, s[40:43], 0 offen offset:768
  buffer_load_dword v8, v9, s[40:43], 0 offen offset:1024
  buffer_load_dwordx4 v[12:15], v10, s[40:43], s15 offen
  buffer_load_dword v16, v10, s[40:43], s15 offen offset:16
  buffer_load_dwordx4 v[128:131], v3, s[44:47], s12 offen nt
  s_add_u32 s12, s12, 12288
  buffer_load_dwordx4 v[132:135], v3, s[44:47], s12 offen nt
  s_add_u32 s12, s12, 12288
  buffer_load_dwordx4 v[136:139], v3, s[44:47], s12 offen nt
  s_add_u32 s12, s12, 12288
L_noq1:
  s_cmp_eq_u32 s4, 3
  s_cbranch_scc0 L_noclr
  v_mov_b32 v56, -1
  v_mov_b32 v57, -1
  v_mov_b32 v58, -1
  v_mov_b32 v59, -1
  v_lshlrev_b32 v55, 4, v0
  s_lshl_b32 s11, s2, 9
  s_add_u32 s11, s11, 65536
  s_mov_b32 exec_hi, 0
  buffer_store_dwordx4 v[56:59], v55, s[48:51], s11 offen sc1
  s_lshr_b32 s10, s6, 3
  s_cmp_lt_u32 s7, 3
  s_cbranch_scc1 L_clr1
  s_mul_i32 s11, s5, 20
  s_mul_i32 s10, s10, 5
  s_add_u32 s11, s11, s10
  s_add_u32 s11, s11, s8
  s_lshl_b32 s11, s11, 7
  s_add_u32 s11, s11, 294912
  s_mov_b64 exec, 0xff
  buffer_store_dwordx4 v[56:59], v55, s[48:51], s11 offen sc1
  s_branch L_clr2
L_clr1:
  s_mul_i32 s10, s10, 3
  s_add_u32 s10, s10, s7
  s_lshl_b32 s10, s10, 3
  s_lshl_b32 s11, s5, 7
  s_add_u32 s11, s11, s10
  s_add_u32 s11, s11, 720896
  s_getreg_b32 s10, hwreg(HW_REG_XCC_ID, 0, 4)
  s_waitcnt lgkmcnt(0)
  s_add_u32 s13, s14, 2654435769
  s_mov_b64 exec, 1
  v_mov_b32 v52, s13
  v_mov_b32 v53, s10
  s_cmp_eq_u32 s7, 2
  s_cbranch_scc1 L_clr4
  s_waitcnt vmcnt(0)
L_clr4:
  buffer_store_dwordx2 v[52:53], off, s[48:51], s11 sc1
L_clr2:
  s_cmp_eq_u32 s7, 3
  s_cbranch_scc0 L_clr3
  s_mov_b64 exec, 1
  s_mul_i32 s11, s6, 384
  s_add_u32 s11, s11, 622592
  v_mov_b32 v54, 928
  buffer_store_dword v54, off, s[48:51], s11 offset:0 sc1
L_clr3:
  s_mov_b64 exec, -1
L_noclr:
  s_cmp_lt_u32 s9, 6
  s_cbranch_scc1 L_q2
  s_barrier
  s_branch L_noq2
L_q2:
  v_mov_b32 v32, 0
  v_mov_b32 v33, 0
  v_mov_b32 v34, 0
  v_mov_b32 v35, 0
  v_mov_b32 v36, 0
  v_mov_b32 v37, 0
  v_mov_b32 v38, 0
  v_mov_b32 v39, 0
  s_waitcnt vmcnt(5)
  s_mov_b32 s26, s12
  buffer_load_dwordx4 v[140:143], v3, s[44:47], s26 offen nt
  s_add_u32 s26, s26, 12288
  buffer_load_dwordx4 v[144:147], v3, s[44:47], s26 offen nt
  s_add_u32 s26, s26, 12288
  buffer_load_dwordx4 v[148:151], v3, s[44:47], s26 offen nt
  s_add_u32 s26, s26, 12288
  buffer_load_dwordx4 v[152:155], v3, s[44:47], s26 offen nt
  s_add_u32 s26, s26, 12288
  buffer_load_dwordx4 v[156:159], v3, s[44:47], s26 offen nt
  s_add_u32 s26, s26, 12288
  buffer_load_dwordx4 v[160:163], v3, s[44:47], s26 offen nt
  s_add_u32 s26, s26, 12288
  buffer_load_dwordx4 v[164:167], v3, s[44:47], s26 offen nt
  s_add_u32 s26, s26, 12288
  v_lshlrev_b32 v22, 16, v4
  v_and_b32 v23, 0xffff0000, v4
  v_lshlrev_b32 v24, 16, v5
  v_and_b32 v25, 0xffff0000, v5
  v_lshlrev_b32 v26, 16, v6
  v_and_b32 v27, 0xffff0000, v6
  v_lshlrev_b32 v28, 16, v7
  v_and_b32 v29, 0xffff0000, v7
  v_lshlrev_b32 v30, 16, v8
  v_and_b32 v31, 0xffff0000, v8
  v_add_f32 v4, v22, v23
  v_add_f32 v4, v4, v24
  v_add_f32 v4, v4, v25
  v_add_f32 v4, v4, v26
  v_add_f32 v4, v4, v27
  v_add_f32 v4, v4, v28
  v_add_f32 v4, v4, v29
  v_add_f32 v4, v4, v30
  v_add_f32 v4, v4, v31
  s_nop 1
  v_add_f32_dpp v4, v4, v4 quad_perm:[1,0,3,2] row_mask:0xf bank_mask:0xf
  s_nop 1
  v_add_f32_dpp v4, v4, v4 quad_perm:[2,3,0,1] row_mask:0xf bank_mask:0xf
  s_nop 1
  v_add_f32_dpp v4, v4, v4 row_half_mirror row_mask:0xf bank_mask:0xf
  s_nop 1
  v_add_f32_dpp v4, v4, v4 row_mirror row_mask:0xf bank_mask:0xf
  s_nop 1
  v_add_f32_dpp v4, v4, v4 row_bcast:15 row_mask:0xa bank_mask:0xf
  s_nop 1
  v_add_f32_dpp v4, v4, v4 row_bcast:31 row_mask:0xc bank_mask:0xf
  s_nop 0
  v_readlane_b32 s12, v4, 63
  v_mov_b32 v5, 0x3acccccd
  s_nop 0
  v_mul_f32 v5, s12, v5
  v_mov_b32 v4, 0
  v_sub_f32 v6, v22, v5
  v_fmac_f32 v4, v6, v6
  v_sub_f32 v6, v23, v5
  v_fmac_f32 v4, v6, v6
  v_sub_f32 v6, v24, v5
  v_fmac_f32 v4, v6, v6
  v_sub_f32 v6, v25, v5
  v_fmac_f32 v4, v6, v6
  v_sub_f32 v6, v26, v5
  v_fmac_f32 v4, v6, v6
  v_sub_f32 v6, v27, v5
  v_fmac_f32 v4, v6, v6
  v_sub_f32 v6, v28, v5
  v_fmac_f32 v4, v6, v6
  v_sub_f32 v6, v29, v5
  v_fmac_f32 v4, v6, v6
  v_sub_f32 v6, v30, v5
  v_fmac_f32 v4, v6, v6
  v_sub_f32 v6, v31, v5
  v_fmac_f32 v4, v6, v6
  s_nop 1
  v_add_f32_dpp v4, v4, v4 quad_perm:[1,0,3,2] row_mask:0xf bank_mask:0xf
  s_nop 1
  v_add_f32_dpp v4, v4, v4 quad_perm:[2,3,0,1] row_mask:0xf bank_mask:0xf
  s_nop 1
  v_add_f32_dpp v4, v4, v4 row_half_mirror row_mask:0xf bank_mask:0xf
  s_nop 1
  v_add_f32_dpp v4, v4, v4 row_mirror row_mask:0xf bank_mask:0xf
  s_nop 1
  v_add_f32_dpp v4, v4, v4 row_bcast:15 row_mask:0xa bank_mask:0xf
  s_nop 1
  v_add_f32_dpp v4, v4, v4 row_bcast:31 row_mask:0xc bank_mask:0xf
  s_nop 0
  v_readlane_b32 s12, v4, 63
  v_mov_b32 v6, 0x3acccccd
  v_cvt_pk_bf16_f32 v5, 0, v5
  v_mul_f32 v6, s12, v6
  v_cvt_pk_bf16_f32 v6, 0, v6
  v_add_f32 v6, 0x3727c5ac, v6
  v_cvt_pk_bf16_f32 v6, 0, v6
  v_sqrt_f32 v6, v6
  s_nop 0
  v_cvt_pk_bf16_f32 v6, 0, v6
  v_rcp_f32 v7, v6
  s_waitcnt vmcnt(10)
  v_lshlrev_b32 v8, 16, v12
  v_sub_f32 v8, v8, v5
  v_cvt_pk_bf16_f32 v8, 0, v8
  v_mul_f32 v9, v8, v7
  v_fma_f32 v10, -v9, v6, v8
  v_fmac_f32 v9, v10, v7
  v_cvt_pk_bf16_f32 v64, v9, 0
  v_cvt_pk_bf16_f32 v65, 0, v9
  v_and_b32 v8, 0xffff0000, v12
  v_sub_f32 v8, v8, v5
  v_cvt_pk_bf16_f32 v8, 0, v8
  v_mul_f32 v9, v8, v7
  v_fma_f32 v10, -v9, v6, v8
  v_fmac_f32 v9, v10, v7
  v_cvt_pk_bf16_f32 v66, v9, 0
  v_cvt_pk_bf16_f32 v67, 0, v9
  v_lshlrev_b32 v8, 16, v13
  v_sub_f32 v8, v8, v5
  v_cvt_pk_bf16_f32 v8, 0, v8
  v_mul_f32 v9, v8, v7
  v_fma_f32 v10, -v9, v6, v8
  v_fmac_f32 v9, v10, v7
  v_cvt_pk_bf16_f32 v68, v9, 0
  v_cvt_pk_bf16_f32 v69, 0, v9
  v_and_b32 v8, 0xffff0000, v13
  v_sub_f32 v8, v8, v5
  v_cvt_pk_bf16_f32 v8, 0, v8
  v_mul_f32 v9, v8, v7
  v_fma_f32 v10, -v9, v6, v8
  v_fmac_f32 v9, v10, v7
  v_cvt_pk_bf16_f32 v70, v9, 0
  v_cvt_pk_bf16_f32 v71, 0, v9
  v_lshlrev_b32 v8, 16, v14
  v_sub_f32 v8, v8, v5
  v_cvt_pk_bf16_f32 v8, 0, v8
  v_mul_f32 v9, v8, v7
  v_fma_f32 v10, -v9, v6, v8
  v_fmac_f32 v9, v10, v7
  v_cvt_pk_bf16_f32 v72, v9, 0
  v_cvt_pk_bf16_f32 v73, 0, v9
  v_and_b32 v8, 0xffff0000, v14
  v_sub_f32 v8, v8, v5
  v_cvt_pk_bf16_f32 v8, 0, v8
  v_mul_f32 v9, v8, v7
  v_fma_f32 v10, -v9, v6, v8
  v_fmac_f32 v9, v10, v7
  v_cvt_pk_bf16_f32 v74, v9, 0
  v_cvt_pk_bf16_f32 v75, 0, v9
  v_lshlrev_b32 v8, 16, v15
  v_sub_f32 v8, v8, v5
  v_cvt_pk_bf16_f32 v8, 0, v8
  v_mul_f32 v9, v8, v7
  v_fma_f32 v10, -v9, v6, v8
  v_fmac_f32 v9, v10, v7
  v_cvt_pk_bf16_f32 v76, v9, 0
  v_cvt_pk_bf16_f32 v77, 0, v9
  v_and_b32 v8, 0xffff0000, v15
  v_sub_f32 v8, v8, v5
  v_cvt_pk_bf16_f32 v8, 0, v8
  v_mul_f32 v9, v8, v7
  v_fma_f32 v10, -v9, v6, v8
  v_fmac_f32 v9, v10, v7
  v_cvt_pk_bf16_f32 v78, v9, 0
  v_cvt_pk_bf16_f32 v79, 0, v9
  v_lshlrev_b32 v8, 16, v16
  v_sub_f32 v8, v8, v5
  v_cvt_pk_bf16_f32 v8, 0, v8
  v_mul_f32 v9, v8, v7
  v_fma_f32 v10, -v9, v6, v8
  v_fmac_f32 v9, v10, v7
  v_cvt_pk_bf16_f32 v80, v9, 0
  v_cvt_pk_bf16_f32 v81, 0, v9
  v_and_b32 v8, 0xffff0000, v16
  v_sub_f32 v8, v8, v5
  v_cvt_pk_bf16_f32 v8, 0, v8
  v_mul_f32 v9, v8, v7
  v_fma_f32 v10, -v9, v6, v8
  v_fmac_f32 v9, v10, v7
  v_cvt_pk_bf16_f32 v82, v9, 0
  v_cvt_pk_bf16_f32 v83, 0, v9
  s_barrier
  s_waitcnt vmcnt(8)
  v_dot2c_f32_bf16 v32, v128, v64
  v_dot2c_f32_bf16 v33, v128, v65
  v_dot2c_f32_bf16 v34, v129, v64
  v_dot2c_f32_bf16 v35, v129, v65
  v_dot2c_f32_bf16 v36, v130, v64
  v_dot2c_f32_bf16 v37, v130, v65
  v_dot2c_f32_bf16 v38, v131, v64
  v_dot2c_f32_bf16 v39, v131, v65
  v_dot2c_f32_bf16 v32, v132, v66
  v_dot2c_f32_bf16 v33, v132, v67
  v_dot2c_f32_bf16 v34, v133, v66
  v_dot2c_f32_bf16 v35, v133, v67
  v_dot2c_f32_bf16 v36, v134, v66
  v_dot2c_f32_bf16 v37, v134, v67
  v_dot2c_f32_bf16 v38, v135, v66
  v_dot2c_f32_bf16 v39, v135, v67
  s_waitcnt vmcnt(6)
  v_dot2c_f32_bf16 v32, v136, v68
  v_dot2c_f32_bf16 v33, v136, v69
  v_dot2c_f32_bf16 v34, v137, v68
  v_dot2c_f32_bf16 v35, v137, v69
  v_dot2c_f32_bf16 v36, v138, v68
  v_dot2c_f32_bf16 v37, v138, v69
  v_dot2c_f32_bf16 v38, v139, v68
  v_dot2c_f32_bf16 v39, v139, v69
  v_dot2c_f32_bf16 v32, v140, v70
  v_dot2c_f32_bf16 v33, v140, v71
  v_dot2c_f32_bf16 v34, v141, v70
  v_dot2c_f32_bf16 v35, v141, v71
  v_dot2c_f32_bf16 v36, v142, v70
  v_dot2c_f32_bf16 v37, v142, v71
  v_dot2c_f32_bf16 v38, v143, v70
  v_dot2c_f32_bf16 v39, v143, v71
  s_waitcnt vmcnt(4)
  v_dot2c_f32_bf16 v32, v144, v72
  v_dot2c_f32_bf16 v33, v144, v73
  v_dot2c_f32_bf16 v34, v145, v72
  v_dot2c_f32_bf16 v35, v145, v73
  v_dot2c_f32_bf16 v36, v146, v72
  v_dot2c_f32_bf16 v37, v146, v73
  v_dot2c_f32_bf16 v38, v147, v72
  v_dot2c_f32_bf16 v39, v147, v73
  v_dot2c_f32_bf16 v32, v148, v74
  v_dot2c_f32_bf16 v33, v148, v75
  v_dot2c_f32_bf16 v34, v149, v74
  v_dot2c_f32_bf16 v35, v149, v75
  v_dot2c_f32_bf16 v36, v150, v74
  v_dot2c_f32_bf16 v37, v150, v75
  v_dot2c_f32_bf16 v38, v151, v74
  v_dot2c_f32_bf16 v39, v151, v75
  s_waitcnt vmcnt(2)
  v_dot2c_f32_bf16 v32, v152, v76
  v_dot2c_f32_bf16 v33, v152, v77
  v_dot2c_f32_bf16 v34, v153, v76
  v_dot2c_f32_bf16 v35, v153, v77
  v_dot2c_f32_bf16 v36, v154, v76
  v_dot2c_f32_bf16 v37, v154, v77
  v_dot2c_f32_bf16 v38, v155, v76
  v_dot2c_f32_bf16 v39, v155, v77
  v_dot2c_f32_bf16 v32, v156, v78
  v_dot2c_f32_bf16 v33, v156, v79
  v_dot2c_f32_bf16 v34, v157, v78
  v_dot2c_f32_bf16 v35, v157, v79
  v_dot2c_f32_bf16 v36, v158, v78
  v_dot2c_f32_bf16 v37, v158, v79
  v_dot2c_f32_bf16 v38, v159, v78
  v_dot2c_f32_bf16 v39, v159, v79
  s_waitcnt vmcnt(0)
  v_dot2c_f32_bf16 v32, v160, v80
  v_dot2c_f32_bf16 v33, v160, v81
  v_dot2c_f32_bf16 v34, v161, v80
  v_dot2c_f32_bf16 v35, v161, v81
  v_dot2c_f32_bf16 v36, v162, v80
  v_dot2c_f32_bf16 v37, v162, v81
  v_dot2c_f32_bf16 v38, v163, v80
  v_dot2c_f32_bf16 v39, v163, v81
  v_dot2c_f32_bf16 v32, v164, v82
  v_dot2c_f32_bf16 v33, v164, v83
  v_dot2c_f32_bf16 v34, v165, v82
  v_dot2c_f32_bf16 v35, v165, v83
  v_dot2c_f32_bf16 v36, v166, v82
  v_dot2c_f32_bf16 v37, v166, v83
  v_dot2c_f32_bf16 v38, v167, v82
  v_dot2c_f32_bf16 v39, v167, v83
  s_nop 2
  v_permlane32_swap_b32 v32, v36
  v_permlane32_swap_b32 v33, v37
  v_permlane32_swap_b32 v34, v38
  v_permlane32_swap_b32 v35, v39
  v_pk_add_f32 v[32:33], v[32:33], v[36:37]
  v_pk_add_f32 v[34:35], v[34:35], v[38:39]
  s_nop 1
  v_permlane16_swap_b32 v32, v34
  v_permlane16_swap_b32 v33, v35
  v_pk_add_f32 v[32:33], v[32:33], v[34:35]
  s_nop 1
  v_add_f32_dpp v34, v32, v32 row_ror:8 row_mask:0xf bank_mask:0x3
  s_nop 1
  v_add_f32_dpp v34, v33, v33 row_ror:8 row_mask:0xf bank_mask:0xc
  v_lshl_add_u32 v8, v2, 3, v1
  s_lshl_b32 s11, s4, 8
  v_lshl_add_u32 v8, v8, 2, s11
  ds_write_b32 v8, v34 offset:1024
  s_mov_b64 exec, 1
  ds_add_rtn_u32 v18, v62, v61 offset:520
  s_mov_b64 exec, -1
  v_lshlrev_b32 v8, 2, v0
  s_waitcnt lgkmcnt(0)
  v_readfirstlane_b32 s11, v18
  s_add_u32 s15, s14, 2654435769
  v_lshlrev_b32 v9, 2, v2
  s_lshl_b32 s12, s6, 11
  s_cmp_lg_u32 s11, 3
  s_cbranch_scc1 L_noq2
  ds_read_b32 v4, v8 offset:1024
  ds_read_b32 v5, v8 offset:1280
  ds_read_b32 v6, v8 offset:1536
  ds_read_b32 v7, v8 offset:1792
  s_lshl_b32 s11, s9, 8
  s_add_u32 s11, s11, s12
  s_waitcnt lgkmcnt(0)
  v_add_f32 v4, v4, v5
  v_add_f32 v6, v6, v7
  v_add_f32 v4, v4, v6
  v_lshrrev_b32 v9, v9, s15
  v_bfi_b32 v4, 15, v9, v4
  buffer_store_dword v4, v8, s[48:51], s11 offen sc1
L_noq2:
  s_waitcnt lgkmcnt(0)
  s_add_u32 s14, s14, 2654435769
  s_cmp_eq_u32 s4, 3
  s_cbranch_scc0 L_qdone
L_lwq:
  ds_read_b32 v63, v62 offset:528
  s_sub_u32 s57, s57, 1
  s_cbranch_scc1 L_lxq
  s_waitcnt lgkmcnt(0)
  v_cmp_gt_u32 vcc, 1, v63
  s_cbranch_vccz L_lxq
  s_sleep 2
  s_branch L_lwq
L_lxq:
  s_mov_b32 s57, 262144
  v_lshlrev_b32 v8, 2, v0
  v_lshlrev_b32 v9, 1, v0
  s_lshl_b32 s11, s6, 11
  v_lshlrev_b32 v11, 2, v2
  v_lshrrev_b32 v11, v11, s14
  v_and_b32 v19, 1, v0
  v_subrev_u32 v20, s6, v19
  v_and_b32 v20, 7, v20
  v_lshlrev_b32 v20, 7, v20
  v_lshl_add_u32 v20, v19, 3, v20
  s_lshr_b32 s12, s6, 3
  s_mul_i32 s12, s12, 24
  s_add_u32 s12, s12, 720896
  s_branch L_qp1
L_qpoll:
  s_sleep 4
L_qp1:
  buffer_load_dword v12, v8, s[48:51], s11 offen offset:0 sc1
  buffer_load_dword v13, v8, s[48:51], s11 offen offset:256 sc1
  buffer_load_dword v14, v8, s[48:51], s11 offen offset:512 sc1
  buffer_load_dword v15, v8, s[48:51], s11 offen offset:768 sc1
  buffer_load_dword v16, v8, s[48:51], s11 offen offset:1024 sc1
  buffer_load_dword v17, v8, s[48:51], s11 offen offset:1280 sc1
  buffer_load_dword v18, v20, s[48:51], s12 offen sc1
  s_sub_u32 s57, s57, 1
  s_cbranch_scc1 L_qgot
  s_waitcnt vmcnt(0)
  v_xor_b32 v10, v11, v12
  v_bitop3_b32 v10, v13, v11, v10 bitop3:0xbe
  v_bitop3_b32 v10, v14, v11, v10 bitop3:0xbe
  v_bitop3_b32 v10, v15, v11, v10 bitop3:0xbe
  v_bitop3_b32 v10, v16, v11, v10 bitop3:0xbe
  v_bitop3_b32 v10, v17, v11, v10 bitop3:0xbe
  v_and_b32 v10, 15, v10
  v_bitop3_b32 v10, v18, s14, v10 bitop3:0xbe
  v_cmp_ne_u32 vcc, 0, v10
  s_cbranch_vccnz L_qpoll
L_qgot:
  s_waitcnt vmcnt(0)
  v_bfi_b32 v12, 15, 8, v12
  v_bfi_b32 v13, 15, 8, v13
  v_bfi_b32 v14, 15, 8, v14
  v_bfi_b32 v15, 15, 8, v15
  v_bfi_b32 v16, 15, 8, v16
  v_bfi_b32 v17, 15, 8, v17
  v_add_f32 v12, v12, v15
  v_cvt_pk_bf16_f32 v12, v12, 0
  ds_write_b16 v9, v12 offset:0
  v_add_f32 v13, v13, v16
  v_cvt_pk_bf16_f32 v13, v13, 0
  ds_write_b16 v9, v13 offset:128
  v_add_f32 v14, v14, v17
  v_cvt_pk_bf16_f32 v14, v14, 0
  ds_write_b16 v9, v14 offset:256
  ds_write_b32 v62, v61 offset:524
  s_mov_b32 s57, 262144
L_qdone:
  s_setprio 0
  s_cmp_lt_u32 s7, 3
  s_cbranch_scc1 L_ffn
  s_branch L_wo
  .p2align 12
L_wo:
  s_mov_b32 s56, s6
  s_mul_i32 s11, s56, 245760
  s_lshl_b32 s12, s8, 8
  s_add_u32 s11, s11, s12
  s_add_u32 s44, s24, s11
  s_addc_u32 s45, s25, 0
  s_mov_b32 s46, 244736
  s_mov_b32 s47, 0x20000
  v_lshrrev_b32 v3, 4, v0
  v_mul_u32_u24 v6, 1280, v3
  v_lshlrev_b32 v4, 1, v3
  v_xor_b32 v4, v4, v0
  v_and_b32 v4, 15, v4
  v_xor_b32 v5, 8, v4
  v_lshl_add_u32 v4, v4, 4, v6
  v_lshl_add_u32 v5, v5, 4, v6
  s_mul_i32 s12, s4, 40960
  s_mul_i32 s13, s4, 8192
  s_add_u32 s13, s13, 8192
  s_lshr_b32 s10, s6, 3
  s_mul_i32 s10, s10, 5
  s_add_u32 s10, s10, s8
  v_bfe_u32 v55, v0, 4, 2
  v_lshl_add_u32 v55, v2, 2, v55
  v_lshlrev_b32 v55, 1, v55
  s_lshl_b32 s15, s10, 6
  s_cmp_eq_u32 s4, 0
  s_cselect_b32 s15, s15, 1280
  buffer_load_ushort v56, v55, s[40:43], s15 offen
  s_mov_b32 s52, s28
  s_mov_b32 s53, s29
  s_mov_b32 s54, 1966080
  s_mov_b32 s55, 0x20000
  s_mov_b32 s60, s30
  s_mov_b32 s61, s31
  s_mov_b32 s62, 1966080
  s_mov_b32 s63, 0x20000
  s_lshr_b32 s65, s6, 3
  s_mul_i32 s65, s65, 160
  s_and_b32 s64, s6, 7
  s_lshl_b32 s64, s64, 2
  s_add_u32 s64, s64, s4
  s_and_b32 s64, s64, -2
  s_mul_i32 s64, s64, 5
  s_add_u32 s64, s64, s65
  s_add_u32 s64, s64, 0
  s_mul_i32 s64, s64, 3072
  s_mul_i32 s65, s5, 384
  s_add_u32 s64, s64, s65
  v_mul_u32_u24 v57, 43, v0
  v_lshrrev_b32 v57, 8, v57
  v_mul_u32_u24 v57, 2688, v57
  v_lshl_add_u32 v57, v0, 6, v57
  s_add_u32 s68, s4, 1
L_lwtw:
  ds_read_b32 v63, v62 offset:512
  s_sub_u32 s57, s57, 1
  s_cbranch_scc1 L_lxtw
  s_waitcnt lgkmcnt(0)
  v_cmp_gt_u32 vcc, s68, v63
  s_cbranch_vccz L_lxtw
  s_sleep 2
  s_branch L_lwtw
L_lxtw:
  s_mov_b32 s57, 262144
  s_lshl_b32 s15, s5, 7
  s_add_u32 s15, s15, 720896
  s_cmp_eq_u32 s4, 0
  s_cselect_b32 s15, s15, 2097152
  v_lshlrev_b32 v54, 3, v0
  s_mov_b64 exec, 0xfff
  buffer_load_dwordx2 v[52:53], v54, s[48:51], s15 offen sc1
  s_mov_b64 exec, -1
  s_mov_b32 m0, s13
  s_add_u32 s13, s13, 1024
  buffer_load_dwordx4 v4, s[44:47], s12 offen nt lds
  s_add_u32 s12, s12, 5120
  s_mov_b32 m0, s13
  s_add_u32 s13, s13, 1024
  buffer_load_dwordx4 v4, s[44:47], s12 offen nt lds
  s_add_u32 s12, s12, 5120
  s_mov_b32 m0, s13
  s_add_u32 s13, s13, 1024
  buffer_load_dwordx4 v4, s[44:47], s12 offen nt lds
  s_add_u32 s12, s12, 5120
  s_mov_b32 m0, s13
  s_add_u32 s13, s13, 1024
  buffer_load_dwordx4 v4, s[44:47], s12 offen nt lds
  s_add_u32 s12, s12, 5120
  s_mov_b32 m0, s13
  s_add_u32 s13, s13, 1024
  buffer_load_dwordx4 v5, s[44:47], s12 offen nt lds
  s_add_u32 s12, s12, 5120
  s_mov_b32 m0, s13
  s_add_u32 s13, s13, 1024
  buffer_load_dwordx4 v5, s[44:47], s12 offen nt lds
  s_add_u32 s12, s12, 5120
  s_mov_b32 m0, s13
  s_add_u32 s13, s13, 1024
  buffer_load_dwordx4 v5, s[44:47], s12 offen nt lds
  s_add_u32 s12, s12, 5120
  s_mov_b32 m0, s13
  s_add_u32 s13, s13, 1024
  buffer_load_dwordx4 v5, s[44:47], s12 offen nt lds
  s_add_u32 s12, s12, 5120
  s_mul_i32 s12, s4, 20480
  s_add_u32 s12, s12, 163840
  s_lshl_b32 s13, s4, 12
  s_add_u32 s13, s13, 40960
  s_and_b32 s15, s4, 1
  s_lshl_b32 s15, s15, 7
  v_xor_b32 v4, s15, v4
L_lwtw2:
  ds_read_b32 v63, v62 offset:536
  s_sub_u32 s57, s57, 1
  s_cbranch_scc1 L_lxtw2
  s_waitcnt lgkmcnt(0)
  v_cmp_gt_u32 vcc, 1, v63
  s_cbranch_vccz L_lxtw2
  s_sleep 1
  s_branch L_lwtw2
L_lxtw2:
  s_mov_b32 s57, 262144
  s_mov_b32 m0, s13
  s_add_u32 s13, s13, 1024
  buffer_load_dwordx4 v4, s[44:47], s12 offen nt lds
  s_add_u32 s12, s12, 5120
  s_mov_b32 m0, s13
  s_add_u32 s13, s13, 1024
  buffer_load_dwordx4 v4, s[44:47], s12 offen nt lds
  s_add_u32 s12, s12, 5120
  s_mov_b32 m0, s13
  s_add_u32 s13, s13, 1024
  buffer_load_dwordx4 v4, s[44:47], s12 offen nt lds
  s_add_u32 s12, s12, 5120
  s_mov_b32 m0, s13
  s_add_u32 s13, s13, 1024
  buffer_load_dwordx4 v4, s[44:47], s12 offen nt lds
  s_add_u32 s12, s12, 5120
  v_bfe_u32 v8, v0, 1, 3
  v_lshlrev_b32 v8, 9, v8
  v_lshl_add_u32 v8, v3, 5, v8
  v_and_b32 v9, 1, v0
  v_lshl_add_u32 v8, v9, 4, v8
  v_lshlrev_b32 v9, 1, v3
  v_xor_b32 v9, v9, v2
  v_lshlrev_b32 v9, 9, v9
  s_lshl_b32 s11, s56, 12
  s_add_u32 s11, s11, 65536
  v_lshlrev_b32 v28, 9, v1
  v_lshl_add_u32 v28, v2, 4, v28
  s_lshl_b32 s15, s4, 7
  s_add_u32 s11, s11, s15
  v_mul_u32_u24 v29, 160, v1
  v_lshl_add_u32 v29, v2, 4, v29
  s_mul_i32 s15, s4, 1280
  v_add_u32 v29, s15, v29
  v_bfe_u32 v8, v0, 1, 3
  v_mul_u32_u24 v8, 160, v8
  v_lshl_add_u32 v8, v3, 5, v8
  v_and_b32 v30, 1, v0
  v_lshl_add_u32 v8, v30, 4, v8
  v_lshrrev_b32 v9, 9, v9
  v_mul_u32_u24 v9, 160, v9
  s_cmp_eq_u32 s4, 3
  s_cselect_b32 s16, 0x01010101, -1
  s_mov_b32 s17, s16
  s_cselect_b32 s18, s14, -1
  s_cselect_b32 s20, s16, 0
  s_mov_b32 s21, s20
  v_mov_b32 v112, 0
  v_mov_b32 v113, 0
  v_mov_b32 v114, 0
  v_mov_b32 v115, 0
  s_mul_i32 s13, s56, 2560
  s_lshl_b32 s15, s8, 9
  s_add_u32 s13, s13, s15
  s_lshl_b32 s15, s4, 7
  s_add_u32 s13, s13, s15
  s_add_u32 s13, s13, 196608
  v_lshlrev_b32 v10, 2, v0
  v_bfe_u32 v4, v0, 2, 2
  v_lshl_add_u32 v5, v3, 4, v4
  v_lshlrev_b32 v5, 8, v5
  v_and_b32 v6, 3, v0
  v_lshl_add_u32 v5, v6, 3, v5
  v_bfe_u32 v6, v0, 2, 3
  s_lshl_b32 s15, s4, 1
  v_xor_b32 v6, s15, v6
  v_xor_b32 v7, 1, v6
  v_lshl_add_u32 v6, v6, 5, v5
  v_lshl_add_u32 v7, v7, 5, v5
  s_movk_i32 s67, 0xff
  v_and_b32 v60, 12, v0
  v_lshlrev_b32 v60, 1, v60
  v_lshrrev_b32 v60, v60, s14
  v_and_b32 v31, 1, v0
  v_cmp_eq_u32 vcc, 0, v31
  v_and_b32 v31, 3, v0
  v_lshlrev_b32 v31, 3, v31
  v_mov_b32 v59, s67
  v_cndmask_b32 v59, 0, v59, vcc
  v_bfe_u32 v31, s14, v31, 8
  s_mov_b64 exec, s[16:17]
  buffer_load_dwordx4 v[112:115], v28, s[48:51], s11 offen sc1
  s_mov_b64 exec, -1
  s_waitcnt vmcnt(5)
  s_mov_b64 exec, 1
  ds_add_u32 v62, v61 offset:532
  s_mov_b64 exec, -1
L_lww:
  ds_read_b32 v63, v62 offset:532
  s_sub_u32 s57, s57, 1
  s_cbranch_scc1 L_lxw
  s_waitcnt lgkmcnt(0)
  v_cmp_gt_u32 vcc, 4, v63
  s_cbranch_vccnz L_lww
L_lxw:
  s_mov_b32 s57, 262144
  ds_read_b64_tr_b16 v[64:65], v6 offset:8192
  ds_read_b64_tr_b16 v[66:67], v6 offset:9216
  ds_read_b64_tr_b16 v[72:73], v6 offset:10240
  ds_read_b64_tr_b16 v[74:75], v6 offset:11264
  ds_read_b64_tr_b16 v[68:69], v7 offset:8192
  ds_read_b64_tr_b16 v[70:71], v7 offset:9216
  ds_read_b64_tr_b16 v[76:77], v7 offset:10240
  ds_read_b64_tr_b16 v[78:79], v7 offset:11264
  ds_read_b64_tr_b16 v[80:81], v6 offset:24576
  ds_read_b64_tr_b16 v[82:83], v6 offset:25600
  ds_read_b64_tr_b16 v[88:89], v6 offset:26624
  ds_read_b64_tr_b16 v[90:91], v6 offset:27648
  ds_read_b64_tr_b16 v[84:85], v7 offset:24576
  ds_read_b64_tr_b16 v[86:87], v7 offset:25600
  ds_read_b64_tr_b16 v[92:93], v7 offset:26624
  ds_read_b64_tr_b16 v[94:95], v7 offset:27648
  s_branch L_op2
L_opoll:
  s_sleep 1
L_op1:
  s_mov_b64 exec, s[16:17]
  buffer_load_dwordx4 v[112:115], v28, s[48:51], s11 offen sc1
  s_mov_b64 exec, -1
L_op2:
  s_sub_u32 s57, s57, 1
  s_cbranch_scc1 L_ogo
  s_waitcnt vmcnt(0)
  v_max3_u32 v30, v112, v113, v114
  v_max_u32 v30, v30, v115
  v_cmp_eq_u32 vcc, -1, v30
  s_cbranch_vccnz L_opoll
L_ogo:
  s_waitcnt vmcnt(0)
  ds_write_b128 v29, v[112:115] offset:57344
  s_waitcnt lgkmcnt(0)
  s_barrier
  ds_read_b64 v[12:13], v9 offset:61184
  ds_read_b128 v[16:19], v8 offset:57344
  ds_read_b128 v[20:23], v8 offset:58624
  ds_read_b128 v[24:27], v8 offset:59904
  ds_read_b64_tr_b16 v[96:97], v6 offset:40960
  ds_read_b64_tr_b16 v[98:99], v6 offset:41984
  ds_read_b64_tr_b16 v[104:105], v6 offset:43008
  ds_read_b64_tr_b16 v[106:107], v6 offset:44032
  ds_read_b64_tr_b16 v[100:101], v7 offset:40960
  ds_read_b64_tr_b16 v[102:103], v7 offset:41984
  ds_read_b64_tr_b16 v[108:109], v7 offset:43008
  ds_read_b64_tr_b16 v[110:111], v7 offset:44032
  s_waitcnt lgkmcnt(11)
  v_max_f32_dpp v15, v13, v13 quad_perm:[1,0,3,2] row_mask:0xf bank_mask:0xf
  s_waitcnt lgkmcnt(10)
  v_mfma_f32_16x16x32_bf16 v[32:35], v[16:19], v[64:67], 0
  v_max_f32_dpp v15, v15, v15 quad_perm:[2,3,0,1] row_mask:0xf bank_mask:0xf
  v_mfma_f32_16x16x32_bf16 v[40:43], v[16:19], v[72:75], 0
  v_mfma_f32_16x16x32_bf16 v[36:39], v[16:19], v[68:71], 0
  v_max_f32_dpp v15, v15, v15 row_half_mirror row_mask:0xf bank_mask:0xf
  v_sub_f32 v11, v13, v15
  v_exp_f32 v11, v11
  v_mfma_f32_16x16x32_bf16 v[44:47], v[16:19], v[76:79], 0
  v_mul_f32 v15, v12, v11
  s_waitcnt lgkmcnt(9)
  v_mfma_f32_16x16x32_bf16 v[32:35], v[20:23], v[80:83], v[32:35]
  v_add_f32_dpp v15, v15, v15 quad_perm:[1,0,3,2] row_mask:0xf bank_mask:0xf
  v_mfma_f32_16x16x32_bf16 v[40:43], v[20:23], v[88:91], v[40:43]
  v_mfma_f32_16x16x32_bf16 v[36:39], v[20:23], v[84:87], v[36:39]
  v_add_f32_dpp v15, v15, v15 quad_perm:[2,3,0,1] row_mask:0xf bank_mask:0xf
  v_mfma_f32_16x16x32_bf16 v[44:47], v[20:23], v[92:95], v[44:47]
  s_waitcnt lgkmcnt(0)
  v_mfma_f32_16x16x32_bf16 v[32:35], v[24:27], v[96:99], v[32:35]
  v_add_f32_dpp v15, v15, v15 row_half_mirror row_mask:0xf bank_mask:0xf
  v_rcp_f32 v15, v15
  v_mfma_f32_16x16x32_bf16 v[40:43], v[24:27], v[104:107], v[40:43]
  v_mul_f32 v11, v11, v15
  v_mfma_f32_16x16x32_bf16 v[36:39], v[24:27], v[100:103], v[36:39]
  v_mfma_f32_16x16x32_bf16 v[44:47], v[24:27], v[108:111], v[44:47]
  s_nop 4
  v_add_f32 v48, v32, v41
  v_add_f32 v50, v34, v43
  s_nop 0
  v_add_f32 v49, v36, v45
  v_add_f32 v51, v38, v47
  v_mul_f32_dpp v48, v11, v48 row_newbcast:0 row_mask:0xf bank_mask:0xf
  v_mul_f32_dpp v50, v11, v50 row_newbcast:1 row_mask:0xf bank_mask:0xf
  v_mul_f32_dpp v49, v11, v49 row_newbcast:0 row_mask:0xf bank_mask:0xf
  v_mul_f32_dpp v51, v11, v51 row_newbcast:1 row_mask:0xf bank_mask:0xf
  v_pk_add_f32 v[48:49], v[48:49], v[50:51]
  s_nop 1
  v_permlane16_swap_b32 v48, v49
  v_add_f32 v48, v48, v49
  v_mov_b32 v49, v48
  s_nop 1
  v_permlane32_swap_b32 v48, v49
  v_add_f32 v48, v48, v49
  v_bfi_b32 v48, v59, v60, v48
  s_mov_b32 exec_hi, 0
  buffer_store_dword v48, v10, s[48:51], s13 offen sc1
  s_bitcmp1_b32 s4, 0
  s_cbranch_scc0 L_nohelp
  s_mov_b32 exec_lo, 4294967295
  s_mov_b32 exec_hi, 268435455
  buffer_load_dword v252, v57, s[52:55], s64 offen
  buffer_load_dword v253, v57, s[60:63], s64 offen
  s_mov_b64 exec, -1
L_nohelp:
  s_sub_u32 s8, s5, s10
  s_and_b32 s8, s8, 7
  s_and_b32 s9, s8, 3
  s_cselect_b32 s9, 0, 1
  s_cmp_eq_u32 s4, 0
  s_cbranch_scc1 L_fin
L_wend:
  s_endpgm
L_fin:
  s_mov_b64 exec, -1
  v_mul_u32_u24 v3, 2560, v1
  v_lshl_add_u32 v3, v2, 4, v3
  s_lshl_b32 s11, s10, 7
  s_add_u32 s20, s11, 327680
  s_add_u32 s21, s11, 368640
  s_add_u32 s22, s11, 409600
  s_add_u32 s23, s11, 450560
  s_add_u32 s24, s11, 491520
  s_add_u32 s25, s11, 532480
  s_mov_b32 s57, 262144
  s_add_u32 s16, s11, 196608
  s_add_u32 s17, s11, 217088
  s_add_u32 s18, s11, 237568
  s_add_u32 s19, s11, 258048
  v_mov_b32 v5, v55
  v_lshlrev_b32 v6, 16, v56
  s_lshl_b32 s15, s10, 6
  s_mov_b32 s44, s34
  s_mov_b32 s45, s35
  s_mov_b32 s46, 1280
  s_mov_b32 s47, 0x20000
  s_mul_i32 s12, s5, 2560
  s_add_u32 s12, s12, s11
  s_add_u32 s12, s12, 294912
  v_mov_b32 v7, v5
  v_writelane_b32 v7, 64, 8
  s_mov_b32 s13, 66
  v_writelane_b32 v7, s13, 9
  s_lshr_b32 s13, s14, 16
  v_writelane_b32 v14, s14, 8
  v_writelane_b32 v14, s13, 9
  s_mov_b32 s32, 0x00ff00ff
  s_mov_b32 s33, 0x00ff00ff
  s_getreg_b32 s66, hwreg(HW_REG_XCC_ID, 0, 4)
  v_xor_b32 v52, s14, v52
  v_bitop3_b32 v52, v53, s66, v52 bitop3:0xbe
  v_cmp_ne_u32 vcc, 0, v52
  s_and_b32 s66, vcc_lo, 0xfff
  s_waitcnt vmcnt(0)
  s_branch L_yp1
L_yp:
  s_sleep 1
L_yp1:
  buffer_load_dwordx4 v[112:115], v3, s[48:51], s16 offen sc1
  buffer_load_dwordx4 v[116:119], v3, s[48:51], s17 offen sc1
  buffer_load_dwordx4 v[120:123], v3, s[48:51], s18 offen sc1
  buffer_load_dwordx4 v[124:127], v3, s[48:51], s19 offen sc1
  s_sub_u32 s57, s57, 1
  s_cselect_b64 s[58:59], 0, -1
  s_waitcnt vmcnt(3)
  v_xor_b32 v112, v31, v112
  v_xor_b32 v114, v31, v114
  v_or_b32 v12, v112, v114
  s_waitcnt vmcnt(2)
  v_xor_b32 v116, v31, v116
  v_xor_b32 v118, v31, v118
  v_or3_b32 v12, v116, v118, v12
  v_pk_add_f32 v[8:9], v[112:113], v[116:117]
  v_pk_add_f32 v[10:11], v[114:115], v[118:119]
  s_waitcnt vmcnt(1)
  v_xor_b32 v120, v31, v120
  v_xor_b32 v122, v31, v122
  v_or3_b32 v12, v120, v122, v12
  v_pk_add_f32 v[8:9], v[8:9], v[120:121]
  v_pk_add_f32 v[10:11], v[10:11], v[122:123]
  s_waitcnt vmcnt(0)
  v_xor_b32 v124, v31, v124
  v_xor_b32 v126, v31, v126
  v_or3_b32 v12, v124, v126, v12
  v_pk_add_f32 v[8:9], v[8:9], v[124:125]
  v_pk_add_f32 v[10:11], v[10:11], v[126:127]
  v_cmp_ne_u32_sdwa vcc, v12, v62 src0_sel:BYTE_0 src1_sel:BYTE_0
  s_and_b64 vcc, vcc, s[58:59]
  s_cbranch_scc1 L_yp
L_ypg:
  v_permlane32_swap_b32 v8, v10
  v_permlane32_swap_b32 v9, v11
  v_pk_add_f32 v[8:9], v[8:9], v[10:11]
  s_nop 1
  v_permlane16_swap_b32 v8, v9
  v_add_f32 v8, v8, v9
  s_nop 1
  v_add_f32_dpp v8, v8, v8 row_ror:8 row_mask:0xf bank_mask:0xf
  v_cvt_pk_bf16_f32 v8, 0, v8
  s_mov_b64 exec, s[32:33]
  v_add_f32 v6, v6, v8
  v_cvt_pk_bf16_f32 v14, v6, 0
  s_mov_b32 exec_lo, 0x00ff03ff
  s_cmp_eq_u32 s66, 0
  s_cbranch_scc0 L_hfar
  buffer_store_short v14, v7, s[48:51], s12 offen
  s_branch L_hsent
L_hfar:
  buffer_store_short v14, v7, s[48:51], s12 offen sc1
L_hsent:
  s_mov_b64 exec, -1
  s_cmp_eq_u32 s9, 1
  s_cbranch_scc0 L_wend
  v_lshrrev_b32 v3, 2, v0
  v_mul_u32_u24 v3, 2560, v3
  v_and_b32 v31, 3, v0
  v_add_u32 v31, s8, v31
  v_lshl_add_u32 v3, v31, 4, v3
  v_and_b32 v31, 3, v31
  v_lshlrev_b32 v31, 3, v31
  v_bfe_u32 v31, s14, v31, 8
  s_lshl_b32 s32, 983055, s8
  s_mov_b32 s33, s32
  s_mov_b32 s57, 262144
  s_cmp_eq_u32 s66, 0
  s_cbranch_scc0 L_hw2
  s_lshl_b32 s12, s5, 7
  s_add_u32 s12, s12, 325632
  v_lshlrev_b32 v9, 2, v0
  s_mov_b64 exec, 0xfff
  s_mov_b32 s57, 64
  v_not_b32 v13, s14
L_hw:
  buffer_load_dword v13, v9, s[48:51], s12 offen sc1
  s_sub_u32 s57, s57, 1
  s_cbranch_scc1 L_hw2
  s_sleep 1
  s_waitcnt vmcnt(1)
  v_cmp_ne_u32 vcc, s14, v13
  s_cbranch_vccnz L_hw
L_hw2:
  s_mov_b64 exec, -1
  s_mov_b32 s57, 262144
  v_cvt_pk_bf16_f32 v6, 0, v6
L_fin1:
L_zp:
  buffer_load_dwordx4 v[128:131], v3, s[48:51], s20 offen sc1
  buffer_load_dwordx4 v[132:135], v3, s[48:51], s21 offen sc1
  buffer_load_dwordx4 v[136:139], v3, s[48:51], s22 offen sc1
  buffer_load_dwordx4 v[140:143], v3, s[48:51], s23 offen sc1
  buffer_load_dwordx4 v[144:147], v3, s[48:51], s24 offen sc1
  buffer_load_dwordx4 v[148:151], v3, s[48:51], s25 offen sc1
  s_sub_u32 s57, s57, 1
  s_cselect_b64 s[58:59], 0, -1
  s_waitcnt vmcnt(5)
  v_xor_b32 v128, v31, v128
  v_xor_b32 v130, v31, v130
  v_or_b32 v12, v128, v130
  s_waitcnt vmcnt(4)
  v_xor_b32 v132, v31, v132
  v_xor_b32 v134, v31, v134
  v_or3_b32 v12, v132, v134, v12
  v_pk_add_f32 v[8:9], v[128:129], v[132:133]
  v_pk_add_f32 v[10:11], v[130:131], v[134:135]
  s_waitcnt vmcnt(3)
  v_xor_b32 v136, v31, v136
  v_xor_b32 v138, v31, v138
  v_or3_b32 v12, v136, v138, v12
  v_pk_add_f32 v[8:9], v[8:9], v[136:137]
  v_pk_add_f32 v[10:11], v[10:11], v[138:139]
  s_waitcnt vmcnt(2)
  v_xor_b32 v140, v31, v140
  v_xor_b32 v142, v31, v142
  v_or3_b32 v12, v140, v142, v12
  v_pk_add_f32 v[8:9], v[8:9], v[140:141]
  v_pk_add_f32 v[10:11], v[10:11], v[142:143]
  s_waitcnt vmcnt(1)
  v_xor_b32 v144, v31, v144
  v_xor_b32 v146, v31, v146
  v_or3_b32 v12, v144, v146, v12
  v_pk_add_f32 v[8:9], v[8:9], v[144:145]
  v_pk_add_f32 v[10:11], v[10:11], v[146:147]
  s_waitcnt vmcnt(0)
  v_xor_b32 v148, v31, v148
  v_xor_b32 v150, v31, v150
  v_or3_b32 v12, v148, v150, v12
  v_pk_add_f32 v[8:9], v[8:9], v[148:149]
  v_pk_add_f32 v[10:11], v[10:11], v[150:151]
  v_cmp_ne_u32_sdwa vcc, v12, v62 src0_sel:BYTE_0 src1_sel:BYTE_0
  s_and_b64 vcc, vcc, s[58:59]
  s_cbranch_scc1 L_zp
L_zpg:
  v_permlane32_swap_b32 v8, v10
  v_permlane32_swap_b32 v9, v11
  v_pk_add_f32 v[8:9], v[8:9], v[10:11]
  s_nop 1
  v_permlane16_swap_b32 v8, v9
  v_add_f32 v8, v8, v9
  s_nop 1
  v_add_f32_dpp v8, v8, v8 row_ror:8 row_mask:0xf bank_mask:0xf
  s_nop 1
  v_add_f32_dpp v8, v8, v8 row_ror:4 row_mask:0xf bank_mask:0xf
  v_cvt_pk_bf16_f32 v8, 0, v8
  v_add_f32 v6, v6, v8
  v_cvt_pk_bf16_f32 v6, v6, 0
  s_mov_b64 exec, s[32:33]
  buffer_store_short v6, v5, s[44:47], s15 offen
  s_or_b32 s8, s8, s10
  s_cbranch_scc1 L_fend
  s_mov_b64 exec, 1
  v_mov_b32 v7, s14
  s_mov_b32 s15, 589824
  buffer_store_dword v7, off, s[48:51], s15
L_fend:
  s_endpgm
  .p2align 12
L_ffn:
  s_mul_i32 s10, s5, 12
  s_lshr_b32 s11, s6, 3
  s_mul_i32 s11, s11, 3
  s_add_u32 s10, s10, s11
  s_add_u32 s10, s10, s7
  s_mov_b32 s44, s28
  s_mov_b32 s45, s29
  s_mov_b32 s46, 1966080
  s_mov_b32 s47, 0x20000
  s_mov_b32 s52, s30
  s_mov_b32 s53, s31
  s_mov_b32 s54, 1966080
  s_mov_b32 s55, 0x20000
  s_mul_i32 s11, s10, 20480
  s_add_u32 s60, s32, s11
  s_addc_u32 s61, s33, 0
  s_mov_b32 s62, 20480
  s_mov_b32 s63, 0x20000
  v_lshrrev_b32 v3, 1, v0
  v_mul_u32_u24 v3, 3072, v3
  v_and_b32 v4, 1, v0
  v_lshl_add_u32 v26, v4, 4, v3
  s_mul_i32 s12, s4, 491520
  s_lshl_b32 s11, s10, 5
  s_add_u32 s12, s12, s11
  s_mul_i32 s15, s4, 10240
  s_add_u32 s15, s15, 8192
  v_lshlrev_b32 v27, 3, v0
  s_mul_i32 s9, s4, 320
  v_and_b32 v13, 15, v0
  v_lshrrev_b32 v3, 4, v0
  v_lshlrev_b32 v28, 3, v13
  v_lshl_add_u32 v28, v3, 8, v28
  v_add_u32 v28, s15, v28
  s_mul_i32 s11, s4, 272
  s_add_u32 s11, s11, 5120
  v_lshl_add_u32 v12, v0, 4, s11
  v_lshlrev_b32 v14, 4, v13
  s_add_u32 s11, s11, 256
  v_add_u32 v15, 6400, v27
  v_writelane_b32 v15, s11, 63
  v_lshlrev_b32 v5, 4, v3
  v_lshlrev_b32 v6, 7, v1
  v_lshl_add_u32 v6, v2, 3, v6
  v_lshlrev_b32 v7, 7, v2
  v_add_u32 v7, 64, v7
  v_cmp_gt_u32 vcc, 40, v0
  s_mul_i32 s11, s4, 640
  s_mul_i32 s13, s10, 2560
  v_cndmask_b32 v6, v7, v6, vcc
  v_lshlrev_b32 v4, 4, v0
  s_lshl_b32 s27, s9, 1
  s_add_u32 s13, s13, s27
  s_add_u32 s13, s13, 327680
  s_add_u32 s11, s11, 294912
  s_mul_i32 s16, s5, 2560
  s_add_u32 s11, s11, s16
  s_movk_i32 s67, 0xff
  v_and_b32 v60, 3, v0
  v_lshlrev_b32 v60, 3, v60
  v_lshrrev_b32 v60, v60, s14
  s_mov_b32 s16, 0
  s_mov_b32 s17, 0x1f00
  s_mov_b32 s18, 0x00010001
  s_mov_b32 s19, 0x00010001
  s_mov_b32 s20, -1
  s_mov_b32 s21, 0x1fff
  s_mov_b32 s24, 0x05040100
  s_mov_b32 s25, 0x07060302
  s_mul_i32 s8, s5, 80
  s_lshl_b32 s26, s10, 2
  s_add_u32 s8, s8, s26
  s_add_u32 s8, s8, 325632
  s_cmp_eq_u32 s4, 3
  s_cselect_b32 s8, s8, 2097152
  v_mov_b32 v52, 2097152
  v_writelane_b32 v52, s8, 0
  v_mov_b32 v53, s14
  v_mov_b32 v8, 0x3f803f80
  v_mov_b32 v32, v8
  v_mov_b32 v33, v8
  v_mov_b32 v34, v8
  v_mov_b32 v35, v8
  v_mov_b32 v36, v8
  v_mov_b32 v37, v8
  v_mov_b32 v38, v8
  v_mov_b32 v39, v8
  v_mov_b32 v40, v8
  v_mov_b32 v41, v8
  v_mov_b32 v42, v8
  v_mov_b32 v43, v8
  v_mov_b32 v44, v8
  v_mov_b32 v45, v8
  v_mov_b32 v46, v8
  v_mov_b32 v47, v8
  v_mov_b32 v48, v8
  v_mov_b32 v49, v8
  v_mov_b32 v50, v8
  v_mov_b32 v51, v8
  s_waitcnt vmcnt(0)
  s_lshr_b32 s65, s6, 3
  s_mul_i32 s65, s65, 160
  s_and_b32 s64, s6, 7
  s_lshl_b32 s64, s64, 2
  s_add_u32 s64, s64, s4
  s_mul_i32 s64, s64, 5
  s_add_u32 s64, s64, s65
  s_add_u32 s64, s64, 0
  s_mul_i32 s64, s64, 3072
  s_mul_i32 s65, s5, 384
  s_add_u32 s64, s64, s65
  v_mul_u32_u24 v57, 43, v0
  v_lshrrev_b32 v57, 8, v57
  v_mul_u32_u24 v57, 2688, v57
  v_lshl_add_u32 v57, v0, 6, v57
L_lwtg:
  ds_read_b32 v63, v62 offset:536
  s_sub_u32 s57, s57, 1
  s_cbranch_scc1 L_lxtg
  s_waitcnt lgkmcnt(0)
  v_cmp_gt_u32 vcc, 1, v63
  s_cbranch_vccz L_lxtg
  s_sleep 1
  s_branch L_lwtg
L_lxtg:
  s_mov_b32 s57, 262144
  s_mov_b32 exec_lo, 1073741823
  s_mov_b32 exec_hi, 0
  buffer_load_dword v252, v57, s[44:47], s64 offen
  buffer_load_dword v253, v57, s[52:55], s64 offen
  s_mov_b64 exec, -1
  s_mov_b32 exec_hi, 0xff
  buffer_load_dwordx2 v[128:129], v27, s[60:63], s9 offen offset:0 nt
  buffer_load_dwordx2 v[130:131], v27, s[60:63], s9 offen offset:1280 nt
  buffer_load_dwordx2 v[132:133], v27, s[60:63], s9 offen offset:2560 nt
  s_add_u32 s9, s9, 3840
  buffer_load_dwordx2 v[134:135], v27, s[60:63], s9 offen offset:0 nt
  buffer_load_dwordx2 v[136:137], v27, s[60:63], s9 offen offset:1280 nt
  buffer_load_dwordx2 v[138:139], v27, s[60:63], s9 offen offset:2560 nt
  s_add_u32 s9, s9, 3840
  buffer_load_dwordx2 v[140:141], v27, s[60:63], s9 offen offset:0 nt
  buffer_load_dwordx2 v[142:143], v27, s[60:63], s9 offen offset:1280 nt
  buffer_load_dwordx2 v[144:145], v27, s[60:63], s9 offen offset:2560 nt
  s_add_u32 s9, s9, 3840
  buffer_load_dwordx2 v[146:147], v27, s[60:63], s9 offen offset:0 nt
  buffer_load_dwordx2 v[148:149], v27, s[60:63], s9 offen offset:1280 nt
  buffer_load_dwordx2 v[150:151], v27, s[60:63], s9 offen offset:2560 nt
  s_add_u32 s9, s9, 3840
  buffer_load_dwordx2 v[152:153], v27, s[60:63], s9 offen offset:0 nt
  buffer_load_dwordx2 v[154:155], v27, s[60:63], s9 offen offset:1280 nt
  buffer_load_dwordx2 v[156:157], v27, s[60:63], s9 offen offset:2560 nt
  s_add_u32 s9, s9, 3840
  buffer_load_dwordx2 v[158:159], v27, s[60:63], s9 offen offset:0 nt
  s_mov_b32 exec_hi, -1
  s_waitcnt vmcnt(12)
  s_mov_b32 m0, s15
  s_add_u32 s15, s15, 1024
  buffer_load_dwordx4 v26, s[44:47], s12 offen  lds
  s_mov_b32 m0, s15
  s_add_u32 s15, s15, 1024
  buffer_load_dwordx4 v26, s[52:55], s12 offen  lds
  s_add_u32 s12, s12, 98304
  s_mov_b32 m0, s15
  s_add_u32 s15, s15, 1024
  buffer_load_dwordx4 v26, s[44:47], s12 offen  lds
  s_mov_b32 m0, s15
  s_add_u32 s15, s15, 1024
  buffer_load_dwordx4 v26, s[52:55], s12 offen  lds
  s_add_u32 s12, s12, 98304
  s_mov_b32 m0, s15
  s_add_u32 s15, s15, 1024
  buffer_load_dwordx4 v26, s[44:47], s12 offen  lds
  s_mov_b32 m0, s15
  s_add_u32 s15, s15, 1024
  buffer_load_dwordx4 v26, s[52:55], s12 offen  lds
  s_add_u32 s12, s12, 98304
  s_mov_b32 m0, s15
  s_add_u32 s15, s15, 1024
  buffer_load_dwordx4 v26, s[44:47], s12 offen  lds
  s_mov_b32 m0, s15
  s_add_u32 s15, s15, 1024
  buffer_load_dwordx4 v26, s[52:55], s12 offen  lds
  s_add_u32 s12, s12, 98304
  s_mov_b32 m0, s15
  s_add_u32 s15, s15, 1024
  buffer_load_dwordx4 v26, s[44:47], s12 offen  lds
  s_mov_b32 m0, s15
  s_add_u32 s15, s15, 1024
  buffer_load_dwordx4 v26, s[52:55], s12 offen  lds
  s_add_u32 s12, s12, 98304
  s_waitcnt vmcnt(10)
  v_perm_b32 v160, v130, v128, s24
  v_perm_b32 v161, v130, v128, s25
  v_perm_b32 v162, v131, v129, s24
  v_perm_b32 v163, v131, v129, s25
  v_perm_b32 v164, v134, v132, s24
  v_perm_b32 v165, v134, v132, s25
  v_perm_b32 v166, v135, v133, s24
  v_perm_b32 v167, v135, v133, s25
  v_perm_b32 v168, v138, v136, s24
  v_perm_b32 v169, v138, v136, s25
  v_perm_b32 v170, v139, v137, s24
  v_perm_b32 v171, v139, v137, s25
  v_perm_b32 v172, v142, v140, s24
  v_perm_b32 v173, v142, v140, s25
  v_perm_b32 v174, v143, v141, s24
  v_perm_b32 v175, v143, v141, s25
  v_perm_b32 v176, v146, v144, s24
  v_perm_b32 v177, v146, v144, s25
  v_perm_b32 v178, v147, v145, s24
  v_perm_b32 v179, v147, v145, s25
  v_perm_b32 v180, v150, v148, s24
  v_perm_b32 v181, v150, v148, s25
  v_perm_b32 v182, v151, v149, s24
  v_perm_b32 v183, v151, v149, s25
  v_perm_b32 v184, v154, v152, s24
  v_perm_b32 v185, v154, v152, s25
  v_perm_b32 v186, v155, v153, s24
  v_perm_b32 v187, v155, v153, s25
  v_perm_b32 v188, v158, v156, s24
  v_perm_b32 v189, v158, v156, s25
  v_perm_b32 v190, v159, v157, s24
  v_perm_b32 v191, v159, v157, s25
  s_waitcnt vmcnt(8)
  ds_read_b64_tr_b16 v[64:65], v28 offset:0
  ds_read_b64_tr_b16 v[66:67], v28 offset:128
  ds_read_b64_tr_b16 v[68:69], v28 offset:1024
  ds_read_b64_tr_b16 v[70:71], v28 offset:1152
  s_waitcnt vmcnt(6)
  ds_read_b64_tr_b16 v[72:73], v28 offset:2048
  ds_read_b64_tr_b16 v[74:75], v28 offset:2176
  ds_read_b64_tr_b16 v[76:77], v28 offset:3072
  ds_read_b64_tr_b16 v[78:79], v28 offset:3200
  s_waitcnt vmcnt(4)
  ds_read_b64_tr_b16 v[80:81], v28 offset:4096
  ds_read_b64_tr_b16 v[82:83], v28 offset:4224
  ds_read_b64_tr_b16 v[84:85], v28 offset:5120
  ds_read_b64_tr_b16 v[86:87], v28 offset:5248
  s_waitcnt vmcnt(2)
  ds_read_b64_tr_b16 v[88:89], v28 offset:6144
  ds_read_b64_tr_b16 v[90:91], v28 offset:6272
  ds_read_b64_tr_b16 v[92:93], v28 offset:7168
  ds_read_b64_tr_b16 v[94:95], v28 offset:7296
  s_waitcnt vmcnt(0)
  ds_read_b64_tr_b16 v[96:97], v28 offset:8192
  ds_read_b64_tr_b16 v[98:99], v28 offset:8320
  ds_read_b64_tr_b16 v[100:101], v28 offset:9216
  ds_read_b64_tr_b16 v[102:103], v28 offset:9344
  s_branch L_hp1
L_hpoll:
  s_sleep 1
L_hp1:
  s_mov_b64 exec, s[20:21]
  buffer_load_dwordx2 v[24:25], v6, s[48:51], s11 offen sc1
  s_mov_b64 exec, s[18:19]
  buffer_load_dwordx4 v[32:35], v5, s[48:51], s11 offen offset:0 sc1
  buffer_load_dwordx4 v[36:39], v5, s[48:51], s11 offen offset:128 sc1
  buffer_load_dwordx4 v[40:43], v5, s[48:51], s11 offen offset:256 sc1
  buffer_load_dwordx4 v[44:47], v5, s[48:51], s11 offen offset:384 sc1
  buffer_load_dwordx4 v[48:51], v5, s[48:51], s11 offen offset:512 sc1
  s_mov_b64 exec, -1
  v_mov_b32 v30, 0
  v_mov_b32 v31, 0
  s_sub_u32 s57, s57, 1
  s_cbranch_scc1 L_hgo
  s_waitcnt vmcnt(5)
  v_cmp_ne_u32 vcc, s14, v24
  s_and_b64 vcc, vcc, s[16:17]
  s_cbranch_scc1 L_hpoll
L_hgo:
  s_waitcnt vmcnt(5) lgkmcnt(0)
  s_mov_b32 exec_hi, 0xff
  v_dot2c_f32_bf16 v30, v24, v8
  v_dot2c_f32_bf16 v31, v24, v24
  v_dot2c_f32_bf16 v30, v25, v8
  v_dot2c_f32_bf16 v31, v25, v25
  s_mov_b32 exec_hi, -1
  s_waitcnt vmcnt(4)
  v_mfma_f32_16x16x32_bf16 v[16:19], v[32:35], v[64:67], 0
  v_mfma_f32_16x16x32_bf16 v[20:23], v[32:35], v[68:71], 0
  v_add_f32_dpp v30, v30, v30 quad_perm:[1,0,3,2] row_mask:0xf bank_mask:0xf
  v_add_f32_dpp v31, v31, v31 quad_perm:[1,0,3,2] row_mask:0xf bank_mask:0xf
  s_waitcnt vmcnt(3)
  v_mfma_f32_16x16x32_bf16 v[16:19], v[36:39], v[72:75], v[16:19]
  v_add_f32_dpp v30, v30, v30 quad_perm:[2,3,0,1] row_mask:0xf bank_mask:0xf
  v_add_f32_dpp v31, v31, v31 quad_perm:[2,3,0,1] row_mask:0xf bank_mask:0xf
  v_mfma_f32_16x16x32_bf16 v[20:23], v[36:39], v[76:79], v[20:23]
  v_add_f32_dpp v30, v30, v30 row_half_mirror row_mask:0xf bank_mask:0xf
  v_add_f32_dpp v31, v31, v31 row_half_mirror row_mask:0xf bank_mask:0xf
  s_waitcnt vmcnt(2)
  v_mfma_f32_16x16x32_bf16 v[16:19], v[40:43], v[80:83], v[16:19]
  v_add_f32_dpp v30, v30, v30 row_mirror row_mask:0xf bank_mask:0xf
  v_add_f32_dpp v31, v31, v31 row_mirror row_mask:0xf bank_mask:0xf
  v_mfma_f32_16x16x32_bf16 v[20:23], v[40:43], v[84:87], v[20:23]
  v_add_f32_dpp v30, v30, v30 row_bcast:15 row_mask:0xa bank_mask:0xf
  v_add_f32_dpp v31, v31, v31 row_bcast:15 row_mask:0xa bank_mask:0xf
  s_waitcnt vmcnt(1)
  v_mfma_f32_16x16x32_bf16 v[16:19], v[44:47], v[88:91], v[16:19]
  v_add_f32_dpp v30, v30, v30 row_bcast:31 row_mask:0xc bank_mask:0xf
  v_add_f32_dpp v31, v31, v31 row_bcast:31 row_mask:0xc bank_mask:0xf
  v_mfma_f32_16x16x32_bf16 v[20:23], v[44:47], v[92:95], v[20:23]
  s_waitcnt vmcnt(0)
  v_mfma_f32_16x16x32_bf16 v[16:19], v[48:51], v[96:99], v[16:19]
  v_mfma_f32_16x16x32_bf16 v[20:23], v[48:51], v[100:103], v[20:23]
  ds_write_b64 v15, v[30:31]
  s_nop 5
  v_cmp_u_f32 vcc, v16, v30
  s_mov_b64 exec, 0xffff
  ds_write2_b64 v12, v[16:17], v[20:21] offset1:1
  s_mov_b64 exec, -1
  s_cbranch_vccz L_hok
  s_cmp_lt_i32 s57, 0
  s_cbranch_scc0 L_hpoll
L_hok:
  s_waitcnt lgkmcnt(0)
  s_barrier
  ds_read_b64 v[104:105], v62 offset:5376
  ds_read_b64 v[106:107], v62 offset:5648
  ds_read_b64 v[108:109], v62 offset:5920
  ds_read_b64 v[110:111], v62 offset:6192
  ds_read_b128 v[192:195], v14 offset:5120
  ds_read_b128 v[196:199], v14 offset:5392
  ds_read_b128 v[200:203], v14 offset:5664
  ds_read_b128 v[204:207], v14 offset:5936
  v_mov_b32 v112, 0
  v_mov_b32 v113, 0
  v_mov_b32 v114, 0
  v_mov_b32 v115, 0
  s_waitcnt lgkmcnt(4)
  v_pk_add_f32 v[104:105], v[104:105], v[106:107]
  v_pk_add_f32 v[108:109], v[108:109], v[110:111]
  v_pk_add_f32 v[104:105], v[104:105], v[108:109]
  v_mul_f32 v104, 0x3acccccd, v104
  v_mul_f32 v105, 0x3acccccd, v105
  v_fma_f32 v105, -v104, v104, v105
  v_maximum3_f32 v105, v105, 0, 0
  v_add_f32 v105, 0x3727c5ac, v105
  v_rcp_f32 v105, v105
  s_waitcnt lgkmcnt(2)
  v_pk_add_f32 v[192:193], v[192:193], v[196:197]
  v_pk_add_f32 v[194:195], v[194:195], v[198:199]
  s_waitcnt lgkmcnt(0)
  v_pk_add_f32 v[200:201], v[200:201], v[204:205]
  v_pk_add_f32 v[202:203], v[202:203], v[206:207]
  v_pk_add_f32 v[192:193], v[192:193], v[200:201]
  v_pk_add_f32 v[194:195], v[194:195], v[202:203]
  v_fma_f32 v16, -v104, v193, v192
  v_fma_f32 v17, -v104, v195, v194
  v_maximum3_f32 v16, v16, 0, 0
  v_mul_f32 v17, v17, v105
  v_mul_f32 v16, v16, v17
  s_nop 1
  v_mov_b32_dpp v17, v16 quad_perm:[1,0,3,2] row_mask:0xf bank_mask:0xf
  v_cvt_pk_bf16_f32 v16, v16, v17
  s_nop 1
  v_dot2c_f32_bf16_dpp v112, v16, v160 row_newbcast:0 row_mask:0xf bank_mask:0xf
  v_dot2c_f32_bf16_dpp v113, v16, v161 row_newbcast:0 row_mask:0xf bank_mask:0xf
  v_dot2c_f32_bf16_dpp v114, v16, v162 row_newbcast:0 row_mask:0xf bank_mask:0xf
  v_dot2c_f32_bf16_dpp v115, v16, v163 row_newbcast:0 row_mask:0xf bank_mask:0xf
  v_dot2c_f32_bf16_dpp v112, v16, v164 row_newbcast:2 row_mask:0xf bank_mask:0xf
  v_dot2c_f32_bf16_dpp v113, v16, v165 row_newbcast:2 row_mask:0xf bank_mask:0xf
  v_dot2c_f32_bf16_dpp v114, v16, v166 row_newbcast:2 row_mask:0xf bank_mask:0xf
  v_dot2c_f32_bf16_dpp v115, v16, v167 row_newbcast:2 row_mask:0xf bank_mask:0xf
  v_dot2c_f32_bf16_dpp v112, v16, v168 row_newbcast:4 row_mask:0xf bank_mask:0xf
  v_dot2c_f32_bf16_dpp v113, v16, v169 row_newbcast:4 row_mask:0xf bank_mask:0xf
  v_dot2c_f32_bf16_dpp v114, v16, v170 row_newbcast:4 row_mask:0xf bank_mask:0xf
  v_dot2c_f32_bf16_dpp v115, v16, v171 row_newbcast:4 row_mask:0xf bank_mask:0xf
  v_dot2c_f32_bf16_dpp v112, v16, v172 row_newbcast:6 row_mask:0xf bank_mask:0xf
  v_dot2c_f32_bf16_dpp v113, v16, v173 row_newbcast:6 row_mask:0xf bank_mask:0xf
  v_dot2c_f32_bf16_dpp v114, v16, v174 row_newbcast:6 row_mask:0xf bank_mask:0xf
  v_dot2c_f32_bf16_dpp v115, v16, v175 row_newbcast:6 row_mask:0xf bank_mask:0xf
  v_dot2c_f32_bf16_dpp v112, v16, v176 row_newbcast:8 row_mask:0xf bank_mask:0xf
  v_dot2c_f32_bf16_dpp v113, v16, v177 row_newbcast:8 row_mask:0xf bank_mask:0xf
  v_dot2c_f32_bf16_dpp v114, v16, v178 row_newbcast:8 row_mask:0xf bank_mask:0xf
  v_dot2c_f32_bf16_dpp v115, v16, v179 row_newbcast:8 row_mask:0xf bank_mask:0xf
  v_dot2c_f32_bf16_dpp v112, v16, v180 row_newbcast:10 row_mask:0xf bank_mask:0xf
  v_dot2c_f32_bf16_dpp v113, v16, v181 row_newbcast:10 row_mask:0xf bank_mask:0xf
  v_dot2c_f32_bf16_dpp v114, v16, v182 row_newbcast:10 row_mask:0xf bank_mask:0xf
  v_dot2c_f32_bf16_dpp v115, v16, v183 row_newbcast:10 row_mask:0xf bank_mask:0xf
  v_dot2c_f32_bf16_dpp v112, v16, v184 row_newbcast:12 row_mask:0xf bank_mask:0xf
  v_dot2c_f32_bf16_dpp v113, v16, v185 row_newbcast:12 row_mask:0xf bank_mask:0xf
  v_dot2c_f32_bf16_dpp v114, v16, v186 row_newbcast:12 row_mask:0xf bank_mask:0xf
  v_dot2c_f32_bf16_dpp v115, v16, v187 row_newbcast:12 row_mask:0xf bank_mask:0xf
  v_dot2c_f32_bf16_dpp v112, v16, v188 row_newbcast:14 row_mask:0xf bank_mask:0xf
  v_dot2c_f32_bf16_dpp v113, v16, v189 row_newbcast:14 row_mask:0xf bank_mask:0xf
  v_dot2c_f32_bf16_dpp v114, v16, v190 row_newbcast:14 row_mask:0xf bank_mask:0xf
  v_dot2c_f32_bf16_dpp v115, v16, v191 row_newbcast:14 row_mask:0xf bank_mask:0xf
  s_mov_b32 exec_hi, 0xff
  v_bfi_b32 v112, s67, v60, v112
  v_bfi_b32 v114, s67, v60, v114
  buffer_store_dwordx4 v[112:115], v4, s[48:51], s13 offen sc1
  buffer_store_dword v53, v52, s[48:51], 0 offen
  s_endpgm
L_end:
  s_endpgm
.section .rodata,"a"
.p2align 6
.amdhsa_kernel sequential_preLN__mha_block_cached__glu_gated_reglu__decode_kernel
  .amdhsa_next_free_vgpr 256
  .amdhsa_next_free_sgpr 102
  .amdhsa_accum_offset 256
  .amdhsa_group_segment_fixed_size 0
  .amdhsa_kernarg_size 96
  .amdhsa_user_sgpr_count 2
  .amdhsa_user_sgpr_kernarg_segment_ptr 1
  .amdhsa_system_sgpr_workgroup_id_x 1
  .amdhsa_float_denorm_mode_32 3
.end_amdhsa_kernel
```
